```python
import torch

def _softmax(x, axis=-1):
    return torch.softmax(x, dim=axis)
def _gelu(x):
    return torch.nn.functional.gelu(x, approximate="tanh")
def _silu(x):
    return torch.nn.functional.silu(x)
def _sigmoid(x):
    return torch.sigmoid(x)
def _layernorm(x, axis=-1, eps=1e-5):
    m = x.mean(dim=axis, keepdim=True)
    v = x.var(dim=axis, keepdim=True, unbiased=False)
    return (x - m) / torch.sqrt(v + eps)
def _scatter_add(tgt, idx, src, axis=0):
    return tgt.clone().index_add_(axis, idx, src)
def _segment_sum(src, seg, n):
    out = torch.zeros((n,) + src.shape[1:], dtype=src.dtype)
    return out.index_add_(0, seg, src)
def _pad(x, pw):
    flat = tuple(v for pair in reversed(pw) for v in pair)
    return torch.nn.functional.pad(x, flat)

kernel_name = 'concat_heads__gqa_block_cached__gqa_block_cached__near_ridge'

def setup_inputs():

    _w = (lambda a: (lambda t: t.to(torch.bfloat16) if t.is_floating_point() else t)(torch.as_tensor(a)))
    def _A_setup():
        B, Sq, D = 8, 64, 576
        Hq, Hkv, Sk, Dh = 32, 16, 512, 128
        assert Hq % Hkv == 0, (Hq, Hkv)
        return {
            "x": _w((lambda *s: torch.randn(*s, dtype=torch.bfloat16) * 0.8)(B, Sq, D)),
            "k_cache": _w((lambda *s: torch.randn(*s, dtype=torch.bfloat16) * 0.8)(B, Hkv, Sk, Dh)),
            "v_cache": _w((lambda *s: torch.randn(*s, dtype=torch.bfloat16) * 0.05)(B, Hkv, Sk, Dh)),
            "wq": _w((lambda *s: torch.randn(*s, dtype=torch.bfloat16) * 0.8)(D, Hq * Dh) * (D ** -0.5)),
            "wo": _w((lambda *s: torch.randn(*s, dtype=torch.bfloat16) * 0.05)(Hq * Dh, D) * ((Hq * Dh) ** -0.5)),
        }
    _A_in = _A_setup()

    def _B_setup():
        B, Sq, D = 8, 64, 576
        Hq, Hkv, Sk, Dh = 32, 16, 512, 128
        assert Hq % Hkv == 0, (Hq, Hkv)
        return {
            "x": _w((lambda *s: torch.randn(*s, dtype=torch.bfloat16) * 0.8)(B, Sq, D)),
            "k_cache": _w((lambda *s: torch.randn(*s, dtype=torch.bfloat16) * 0.8)(B, Hkv, Sk, Dh)),
            "v_cache": _w((lambda *s: torch.randn(*s, dtype=torch.bfloat16) * 0.05)(B, Hkv, Sk, Dh)),
            "wq": _w((lambda *s: torch.randn(*s, dtype=torch.bfloat16) * 0.8)(D, Hq * Dh) * (D ** -0.5)),
            "wo": _w((lambda *s: torch.randn(*s, dtype=torch.bfloat16) * 0.05)(Hq * Dh, D) * ((Hq * Dh) ** -0.5)),
        }
    _B_in = _B_setup()

    return {
        "A_x": _A_in["x"],
        "A_k_cache": _A_in["k_cache"],
        "A_v_cache": _A_in["v_cache"],
        "A_wq": _A_in["wq"],
        "A_wo": _A_in["wo"],
        "B_x": _B_in["x"],
        "B_k_cache": _B_in["k_cache"],
        "B_v_cache": _B_in["v_cache"],
        "B_wq": _B_in["wq"],
        "B_wo": _B_in["wo"],
    }

def reference(A_x, A_k_cache, A_v_cache, A_wq, A_wo, B_x, B_k_cache, B_v_cache, B_wq, B_wo):
    def _A_ref(x, k_cache, v_cache, wq, wo):
        B, Sq, D = x.shape
        Hq, Dh = 32, 128
        Hkv = k_cache.shape[1]
        rep = Hq // Hkv
        q = (lambda x, *d: x.permute(*d))((x @ wq).reshape(B, Sq, Hq, Dh), 0, 2, 1, 3)
        k = (lambda x, n, axis: torch.repeat_interleave(x, n, dim=axis))(k_cache, rep, axis=1)
        v = (lambda x, n, axis: torch.repeat_interleave(x, n, dim=axis))(v_cache, rep, axis=1)
        scores = torch.einsum("bhqd,bhkd->bhqk", q, k) * (Dh ** -0.5)
        p = _softmax(scores, axis=-1)
        o = torch.einsum("bhqk,bhkd->bhqd", p, v)
        return (lambda x, *d: x.permute(*d))(o, 0, 2, 1, 3).reshape(B, Sq, Hq * Dh) @ wo

    def _B_ref(x, k_cache, v_cache, wq, wo):
        B, Sq, D = x.shape
        Hq, Dh = 32, 128
        Hkv = k_cache.shape[1]
        rep = Hq // Hkv
        q = (lambda x, *d: x.permute(*d))((x @ wq).reshape(B, Sq, Hq, Dh), 0, 2, 1, 3)
        k = (lambda x, n, axis: torch.repeat_interleave(x, n, dim=axis))(k_cache, rep, axis=1)
        v = (lambda x, n, axis: torch.repeat_interleave(x, n, dim=axis))(v_cache, rep, axis=1)
        scores = torch.einsum("bhqd,bhkd->bhqk", q, k) * (Dh ** -0.5)
        p = _softmax(scores, axis=-1)
        o = torch.einsum("bhqk,bhkd->bhqd", p, v)
        return (lambda x, *d: x.permute(*d))(o, 0, 2, 1, 3).reshape(B, Sq, Hq * Dh) @ wo

    a = _A_ref(A_x, A_k_cache, A_v_cache, A_wq, A_wo)
    b = _B_ref(B_x, B_k_cache, B_v_cache, B_wq, B_wo)
    return torch.concatenate([a, b], axis=-1)
```

```asm
; @launch grid=(256,1,1) block=(512,1,1) lds=163840
.amdgcn_target "amdgcn-amd-amdhsa--gfx950"
.text
.globl concat_heads__gqa_block_cached__gqa_block_cached__near_ridge_kernel
.p2align 8
.type concat_heads__gqa_block_cached__gqa_block_cached__near_ridge_kernel,@function
concat_heads__gqa_block_cached__gqa_block_cached__near_ridge_kernel:
    s_cmp_ge_u32 s2, 256
    s_cbranch_scc1 L_end
    s_getreg_b32 s3, hwreg(HW_REG_XCC_ID, 0, 3)
    s_getreg_b32 s6, hwreg(HW_REG_HW_ID, 13, 2)
    s_getreg_b32 s7, hwreg(HW_REG_HW_ID, 8, 4)
    s_brev_b32 s3, s3
    s_lshr_b32 s3, s3, 29
    s_lshr_b32 s71, s7, 2
    s_and_b32 s71, s71, 2
    s_and_b32 s7, s7, 7
    s_lshl2_add_u32 s3, s3, s6
    s_lshl3_add_u32 s2, s3, s7
L_restart:
    s_lshr_b32 s6, s2, 7
    s_bfe_u32 s7, s2, 0x40003
    s_and_b32 s8, s2, 7
    v_lshrrev_b32 v1, 6, v0
    s_cmp_eq_u32 s6, 0
    s_cbranch_scc1 L_brA
    s_load_dwordx8 s[12:19], s[0:1], 40
    s_load_dwordx2 s[20:21], s[0:1], 72
    s_branch L_brB
L_brA:
    s_load_dwordx8 s[12:19], s[0:1], 0
    s_load_dwordx2 s[20:21], s[0:1], 32
L_brB:
    v_readfirstlane_b32 s9, v1
    s_load_dwordx2 s[94:95], s[0:1], 80
    s_load_dwordx4 s[96:99], s[0:1], 88
    s_and_b32 s10, s9, 3
    s_cmp_lt_u32 s9, 4
    s_cbranch_scc1 L_compute
    v_and_b32 v1, 63, v0
    v_and_b32 v2, 3, v1
    v_bfe_u32 v3, v1, 2, 2
    v_lshrrev_b32 v4, 4, v1
    s_lshl_b32 s3, s10, 12
    s_lshl_b32 s22, s10, 11
    s_lshl_b32 s23, s10, 13
    v_lshlrev_b32 v5, 6, v4
    v_lshl_add_u32 v5, v2, 4, v5
    s_and_b32 s60, s10, 1
    s_lshl_b32 s60, s60, 17
    s_lshr_b32 s61, s10, 1
    s_lshl_b32 s61, s61, 8
    s_add_u32 s60, s60, s61
    v_lshl_add_u32 v10, v3, 13, v5
    v_add_u32 v10, s60, v10
    v_add_u32 v11, 31744, v10
    v_add_u32 v12, 63488, v10
    v_add_u32 v13, 95232, v10
    v_lshrrev_b32 v6, 3, v1
    s_lshl_b32 s60, s10, 4
    v_add_u32 v6, s60, v6
    v_mul_u32_u24 v6, 1152, v6
    v_and_b32 v7, 7, v1
    v_xor_b32 v7, v7, v4
    v_lshl_add_u32 v14, v7, 4, v6
    v_xor_b32 v15, 64, v14
    v_add_u32 v15, 8192, v15
    s_lshl_b32 s60, s8, 1
    s_and_b32 s61, s7, 3
    s_lshl2_add_u32 s60, s61, s60
    s_cmp_eq_u32 s61, 3
    s_cselect_b32 s61, 2, 0
    s_add_u32 s60, s60, s61
    s_cmp_ge_u32 s60, 18
    s_cselect_b32 s61, 18, 0
    s_sub_u32 s60, s60, s61
    s_lshl_b32 s61, s7, 9
    s_lshl_b32 s56, s60, 18
    s_add_u32 s56, s56, s61
    s_add_u32 s58, s61, 4718592
    s_mul_i32 s57, s8, 73728
    s_add_u32 s62, s57, 1152
    s_lshl_b32 s60, s60, 6
    s_add_u32 s57, s57, s60
    s_mov_b32 s69, s57
    s_waitcnt lgkmcnt(0)
    s_cmp_lg_u32 s9, 4
    s_cselect_b32 s60, 1, s71
    s_cmp_lg_u32 s60, 0
    s_mov_b32 s70, 0
    s_cbranch_scc1 L_noclaim
    s_and_b32 s63, s2, 0xe0
    s_add_u32 s63, s63, 8
    s_lshl_b32 s70, 1, s2
    s_atomic_or s70, s[96:97], s63 glc
L_noclaim:
    s_mov_b32 s28, s18
    s_mov_b32 s29, s19
    s_mov_b32 s30, 4718592
    s_mov_b32 s31, 0x20000
    s_mov_b32 s24, s12
    s_mov_b32 s25, s13
    s_mov_b32 s26, 589824
    s_mov_b32 s27, 0x20000
    s_and_b32 s60, s8, 3
    s_cmp_eq_u32 s60, 1
    s_cbranch_scc1 L_plan1
    s_cmp_eq_u32 s60, 2
    s_cbranch_scc1 L_plan2
    s_cmp_eq_u32 s60, 3
    s_cbranch_scc1 L_plan3
    s_add_u32 m0, s22, 32768
    s_nop 0
    buffer_load_dwordx4 v14, s[24:27], s57 offen offset:0  lds
    buffer_load_dwordx4 v15, s[24:27], s57 offen offset:1024  lds
    s_add_u32 s57, s57, 128
    s_cmp_eq_u32 s57, s62
    s_cselect_b32 s60, 1152, 0
    s_sub_u32 s57, s57, s60
    s_add_u32 m0, s3, 0
    s_nop 0
    buffer_load_dwordx4 v10, s[28:31], s56 offen offset:0  lds
    buffer_load_dwordx4 v11, s[28:31], s56 offen offset:1024  lds
    buffer_load_dwordx4 v12, s[28:31], s56 offen offset:2048  lds
    buffer_load_dwordx4 v13, s[28:31], s56 offen offset:3072  lds
    s_add_u32 s56, s56, 262144
    s_mov_b32 s32, s14
    s_mov_b32 s33, s15
    s_mov_b32 s34, 16777216
    s_mov_b32 s35, 0x20000
    s_mov_b32 s36, s16
    s_mov_b32 s37, s17
    s_mov_b32 s38, 16777216
    s_mov_b32 s39, 0x20000
    s_mov_b32 s40, s20
    s_mov_b32 s41, s21
    s_mov_b32 s42, 4718592
    s_mov_b32 s43, 0x20000
    v_lshl_add_u32 v8, v3, 8, v5
    v_add_u32 v16, s3, v8
    v_xor_b32 v17, 16, v16
    v_xor_b32 v18, 32, v16
    v_xor_b32 v19, 48, v16
    s_lshl_b32 s59, s8, 21
    s_lshl_b32 s60, s7, 17
    s_add_u32 s59, s59, s60
    s_add_u32 s60, s7, s8
    s_and_b32 s60, s60, 7
    s_lshl_b32 s60, s60, 14
    s_or_b32 s59, s59, s60
    s_add_u32 m0, s3, 16384
    s_nop 0
    buffer_load_dwordx4 v10, s[28:31], s56 offen offset:0  lds
    buffer_load_dwordx4 v11, s[28:31], s56 offen offset:1024  lds
    buffer_load_dwordx4 v12, s[28:31], s56 offen offset:2048  lds
    buffer_load_dwordx4 v13, s[28:31], s56 offen offset:3072  lds
    s_add_u32 s56, s56, 262144
    s_cmp_eq_u32 s56, s58
    s_cselect_b32 s60, 4718592, 0
    s_sub_u32 s56, s56, s60
    s_add_u32 m0, s22, 40960
    s_nop 0
    buffer_load_dwordx4 v14, s[24:27], s57 offen offset:0  lds
    buffer_load_dwordx4 v15, s[24:27], s57 offen offset:1024  lds
    s_add_u32 s57, s57, 128
    s_cmp_eq_u32 s57, s62
    s_cselect_b32 s60, 1152, 0
    s_sub_u32 s57, s57, s60
    s_add_u32 m0, s3, 49152
    s_nop 0
    buffer_load_dwordx4 v10, s[28:31], s56 offen offset:0  lds
    buffer_load_dwordx4 v11, s[28:31], s56 offen offset:1024  lds
    buffer_load_dwordx4 v12, s[28:31], s56 offen offset:2048  lds
    buffer_load_dwordx4 v13, s[28:31], s56 offen offset:3072  lds
    s_add_u32 s56, s56, 262144
    v_mov_b32 v31, 65536
    s_cmp_eq_u32 s71, 2
    s_cbranch_scc1 L_find
L_go0:
    s_waitcnt vmcnt(10)
    s_barrier
    s_add_u32 m0, s3, 65536
    s_nop 0
    buffer_load_dwordx4 v10, s[28:31], s56 offen offset:0  lds
    buffer_load_dwordx4 v11, s[28:31], s56 offen offset:1024  lds
    buffer_load_dwordx4 v12, s[28:31], s56 offen offset:2048  lds
    buffer_load_dwordx4 v13, s[28:31], s56 offen offset:3072  lds
    s_add_u32 s56, s56, 262144
    s_cmp_eq_u32 s56, s58
    s_cselect_b32 s60, 4718592, 0
    s_sub_u32 s56, s56, s60
    s_waitcnt vmcnt(10)
    s_barrier
    s_add_u32 m0, s3, 0
    s_nop 0
    buffer_load_dwordx4 v10, s[28:31], s56 offen offset:0  lds
    buffer_load_dwordx4 v11, s[28:31], s56 offen offset:1024  lds
    buffer_load_dwordx4 v12, s[28:31], s56 offen offset:2048  lds
    buffer_load_dwordx4 v13, s[28:31], s56 offen offset:3072  lds
    s_add_u32 s56, s56, 262144
    s_add_u32 m0, s3, 131072
    s_xor_b32 s60, s59, 0
    buffer_load_dwordx4 v16, s[32:35], s60 offen offset:0 nt lds
    buffer_load_dwordx4 v17, s[32:35], s60 offen offset:1024 nt lds
    buffer_load_dwordx4 v18, s[32:35], s60 offen offset:2048 nt lds
    buffer_load_dwordx4 v19, s[32:35], s60 offen offset:3072 nt lds
    s_add_u32 m0, s3, 147456
    s_xor_b32 s60, s59, 16384
    buffer_load_dwordx4 v16, s[32:35], s60 offen offset:0 nt lds
    buffer_load_dwordx4 v17, s[32:35], s60 offen offset:1024 nt lds
    buffer_load_dwordx4 v18, s[32:35], s60 offen offset:2048 nt lds
    buffer_load_dwordx4 v19, s[32:35], s60 offen offset:3072 nt lds
    s_add_u32 m0, s3, 81920
    s_xor_b32 s60, s59, 0
    buffer_load_dwordx4 v16, s[36:39], s60 offen offset:0 nt lds
    buffer_load_dwordx4 v16, s[36:39], s60 offen offset:1024 nt lds
    buffer_load_dwordx4 v16, s[36:39], s60 offen offset:2048 nt lds
    buffer_load_dwordx4 v16, s[36:39], s60 offen offset:3072 nt lds
    s_add_u32 m0, s3, 98304
    s_xor_b32 s60, s59, 32768
    buffer_load_dwordx4 v16, s[32:35], s60 offen offset:0 nt lds
    buffer_load_dwordx4 v17, s[32:35], s60 offen offset:1024 nt lds
    buffer_load_dwordx4 v18, s[32:35], s60 offen offset:2048 nt lds
    buffer_load_dwordx4 v19, s[32:35], s60 offen offset:3072 nt lds
    s_add_u32 m0, s3, 114688
    s_xor_b32 s60, s59, 49152
    buffer_load_dwordx4 v16, s[32:35], s60 offen offset:0 nt lds
    buffer_load_dwordx4 v17, s[32:35], s60 offen offset:1024 nt lds
    buffer_load_dwordx4 v18, s[32:35], s60 offen offset:2048 nt lds
    buffer_load_dwordx4 v19, s[32:35], s60 offen offset:3072 nt lds
    v_lshrrev_b32 v6, 5, v1
    v_lshl_add_u32 v6, v6, 2, v3
    s_lshl_b32 s60, s10, 5
    v_add_u32 v6, s60, v6
    v_mul_u32_u24 v6, 1152, v6
    v_and_b32 v7, 1, v4
    v_lshlrev_b32 v7, 6, v7
    v_lshl_add_u32 v7, v2, 4, v7
    v_add_u32 v20, v6, v7
    v_add_u32 v21, 8192, v20
    v_add_u32 v22, 16384, v20
    v_add_u32 v23, 24576, v20
    s_mul_i32 s67, s7, 294912
    v_lshlrev_b32 v26, 4, v1
    v_add_u32 v26, s3, v26
    v_add_u32 v27, 98304, v26
    s_mov_b32 s48, s94
    s_mov_b32 s49, s95
    s_mov_b32 s50, 1179648
    s_mov_b32 s51, 0x20000
    s_mov_b32 s52, s96
    s_mov_b32 s53, s97
    s_mov_b32 s54, 256
    s_mov_b32 s55, 0x20000
    s_mov_b32 s44, s98
    s_mov_b32 s45, s99
    s_mov_b32 s46, 18911232
    s_mov_b32 s47, 0x20000
    s_waitcnt vmcnt(28)
    s_barrier
    s_add_u32 m0, s22, 32768
    s_nop 0
    buffer_load_dwordx4 v14, s[24:27], s57 offen offset:0  lds
    buffer_load_dwordx4 v15, s[24:27], s57 offen offset:1024  lds
    s_add_u32 s57, s57, 128
    s_cmp_eq_u32 s57, s62
    s_cselect_b32 s60, 1152, 0
    s_sub_u32 s57, s57, s60
    s_add_u32 m0, s3, 16384
    s_nop 0
    buffer_load_dwordx4 v10, s[28:31], s56 offen offset:0  lds
    buffer_load_dwordx4 v11, s[28:31], s56 offen offset:1024  lds
    buffer_load_dwordx4 v12, s[28:31], s56 offen offset:2048  lds
    buffer_load_dwordx4 v13, s[28:31], s56 offen offset:3072  lds
    s_add_u32 s56, s56, 262144
    s_cmp_eq_u32 s56, s58
    s_cselect_b32 s60, 4718592, 0
    s_sub_u32 s56, s56, s60
    s_waitcnt vmcnt(30)
    s_barrier
    s_add_u32 m0, s3, 49152
    s_nop 0
    buffer_load_dwordx4 v10, s[28:31], s56 offen offset:0  lds
    buffer_load_dwordx4 v11, s[28:31], s56 offen offset:1024  lds
    buffer_load_dwordx4 v12, s[28:31], s56 offen offset:2048  lds
    buffer_load_dwordx4 v13, s[28:31], s56 offen offset:3072  lds
    s_add_u32 s56, s56, 262144
    s_waitcnt vmcnt(8)
    s_barrier
    s_add_u32 m0, s22, 40960
    s_nop 0
    buffer_load_dwordx4 v14, s[24:27], s57 offen offset:0  lds
    buffer_load_dwordx4 v15, s[24:27], s57 offen offset:1024  lds
    s_add_u32 s57, s57, 128
    s_cmp_eq_u32 s57, s62
    s_cselect_b32 s60, 1152, 0
    s_sub_u32 s57, s57, s60
    s_add_u32 m0, s3, 65536
    s_nop 0
    buffer_load_dwordx4 v10, s[28:31], s56 offen offset:0  lds
    buffer_load_dwordx4 v11, s[28:31], s56 offen offset:1024  lds
    buffer_load_dwordx4 v12, s[28:31], s56 offen offset:2048  lds
    buffer_load_dwordx4 v13, s[28:31], s56 offen offset:3072  lds
    s_add_u32 s56, s56, 262144
    s_cmp_eq_u32 s56, s58
    s_cselect_b32 s60, 4718592, 0
    s_sub_u32 s56, s56, s60
    s_waitcnt vmcnt(10)
    s_barrier
    s_add_u32 m0, s3, 0
    s_nop 0
    buffer_load_dwordx4 v10, s[28:31], s56 offen offset:0  lds
    buffer_load_dwordx4 v11, s[28:31], s56 offen offset:1024  lds
    buffer_load_dwordx4 v12, s[28:31], s56 offen offset:2048  lds
    buffer_load_dwordx4 v13, s[28:31], s56 offen offset:3072  lds
    s_add_u32 s56, s56, 262144
    s_waitcnt vmcnt(8)
    s_barrier
    s_add_u32 m0, s22, 32768
    s_nop 0
    buffer_load_dwordx4 v14, s[24:27], s57 offen offset:0  lds
    buffer_load_dwordx4 v15, s[24:27], s57 offen offset:1024  lds
    s_add_u32 s57, s57, 128
    s_cmp_eq_u32 s57, s62
    s_cselect_b32 s60, 1152, 0
    s_sub_u32 s57, s57, s60
    s_add_u32 m0, s3, 16384
    s_nop 0
    buffer_load_dwordx4 v10, s[28:31], s56 offen offset:0  lds
    buffer_load_dwordx4 v11, s[28:31], s56 offen offset:1024  lds
    buffer_load_dwordx4 v12, s[28:31], s56 offen offset:2048  lds
    buffer_load_dwordx4 v13, s[28:31], s56 offen offset:3072  lds
    s_add_u32 s56, s56, 262144
    s_cmp_eq_u32 s56, s58
    s_cselect_b32 s60, 4718592, 0
    s_sub_u32 s56, s56, s60
    s_waitcnt vmcnt(10)
    s_barrier
    s_add_u32 m0, s3, 49152
    s_nop 0
    buffer_load_dwordx4 v10, s[28:31], s56 offen offset:0  lds
    buffer_load_dwordx4 v11, s[28:31], s56 offen offset:1024  lds
    buffer_load_dwordx4 v12, s[28:31], s56 offen offset:2048  lds
    buffer_load_dwordx4 v13, s[28:31], s56 offen offset:3072  lds
    s_add_u32 s56, s56, 262144
    s_waitcnt vmcnt(8)
    s_barrier
    s_add_u32 m0, s22, 40960
    s_nop 0
    buffer_load_dwordx4 v14, s[24:27], s57 offen offset:0  lds
    buffer_load_dwordx4 v15, s[24:27], s57 offen offset:1024  lds
    s_add_u32 s57, s57, 128
    s_cmp_eq_u32 s57, s62
    s_cselect_b32 s60, 1152, 0
    s_sub_u32 s57, s57, s60
    s_add_u32 m0, s3, 65536
    s_nop 0
    buffer_load_dwordx4 v10, s[28:31], s56 offen offset:0  lds
    buffer_load_dwordx4 v11, s[28:31], s56 offen offset:1024  lds
    buffer_load_dwordx4 v12, s[28:31], s56 offen offset:2048  lds
    buffer_load_dwordx4 v13, s[28:31], s56 offen offset:3072  lds
    s_add_u32 s56, s56, 262144
    s_cmp_eq_u32 s56, s58
    s_cselect_b32 s60, 4718592, 0
    s_sub_u32 s56, s56, s60
    s_waitcnt vmcnt(10)
    s_barrier
    s_add_u32 m0, s3, 0
    s_nop 0
    buffer_load_dwordx4 v10, s[28:31], s56 offen offset:0  lds
    buffer_load_dwordx4 v11, s[28:31], s56 offen offset:1024  lds
    buffer_load_dwordx4 v12, s[28:31], s56 offen offset:2048  lds
    buffer_load_dwordx4 v13, s[28:31], s56 offen offset:3072  lds
    s_add_u32 s56, s56, 262144
    s_waitcnt vmcnt(8)
    s_barrier
    s_add_u32 m0, s22, 32768
    s_nop 0
    buffer_load_dwordx4 v14, s[24:27], s57 offen offset:0  lds
    buffer_load_dwordx4 v15, s[24:27], s57 offen offset:1024  lds
    s_add_u32 s57, s57, 128
    s_cmp_eq_u32 s57, s62
    s_cselect_b32 s60, 1152, 0
    s_sub_u32 s57, s57, s60
    s_add_u32 m0, s3, 16384
    s_nop 0
    buffer_load_dwordx4 v10, s[28:31], s56 offen offset:0  lds
    buffer_load_dwordx4 v11, s[28:31], s56 offen offset:1024  lds
    buffer_load_dwordx4 v12, s[28:31], s56 offen offset:2048  lds
    buffer_load_dwordx4 v13, s[28:31], s56 offen offset:3072  lds
    s_add_u32 s56, s56, 262144
    s_cmp_eq_u32 s56, s58
    s_cselect_b32 s60, 4718592, 0
    s_sub_u32 s56, s56, s60
    s_waitcnt vmcnt(10)
    s_barrier
    s_add_u32 m0, s3, 49152
    s_nop 0
    buffer_load_dwordx4 v10, s[28:31], s56 offen offset:0  lds
    buffer_load_dwordx4 v11, s[28:31], s56 offen offset:1024  lds
    buffer_load_dwordx4 v12, s[28:31], s56 offen offset:2048  lds
    buffer_load_dwordx4 v13, s[28:31], s56 offen offset:3072  lds
    s_add_u32 s56, s56, 262144
    s_waitcnt vmcnt(8)
    s_barrier
    s_add_u32 m0, s22, 40960
    s_nop 0
    buffer_load_dwordx4 v14, s[24:27], s57 offen offset:0  lds
    buffer_load_dwordx4 v15, s[24:27], s57 offen offset:1024  lds
    s_add_u32 s57, s57, 128
    s_cmp_eq_u32 s57, s62
    s_cselect_b32 s60, 1152, 0
    s_sub_u32 s57, s57, s60
    s_add_u32 m0, s3, 65536
    s_nop 0
    buffer_load_dwordx4 v10, s[28:31], s56 offen offset:0  lds
    buffer_load_dwordx4 v11, s[28:31], s56 offen offset:1024  lds
    buffer_load_dwordx4 v12, s[28:31], s56 offen offset:2048  lds
    buffer_load_dwordx4 v13, s[28:31], s56 offen offset:3072  lds
    s_add_u32 s56, s56, 262144
    s_cmp_eq_u32 s56, s58
    s_cselect_b32 s60, 4718592, 0
    s_sub_u32 s56, s56, s60
    s_waitcnt vmcnt(10)
    s_barrier
    s_add_u32 m0, s3, 0
    s_nop 0
    buffer_load_dwordx4 v10, s[28:31], s56 offen offset:0  lds
    buffer_load_dwordx4 v11, s[28:31], s56 offen offset:1024  lds
    buffer_load_dwordx4 v12, s[28:31], s56 offen offset:2048  lds
    buffer_load_dwordx4 v13, s[28:31], s56 offen offset:3072  lds
    s_add_u32 s56, s56, 262144
    s_waitcnt vmcnt(8)
    s_barrier
    s_add_u32 m0, s22, 32768
    s_nop 0
    buffer_load_dwordx4 v14, s[24:27], s57 offen offset:0  lds
    buffer_load_dwordx4 v15, s[24:27], s57 offen offset:1024  lds
    s_add_u32 m0, s3, 16384
    s_nop 0
    buffer_load_dwordx4 v10, s[28:31], s56 offen offset:0  lds
    buffer_load_dwordx4 v11, s[28:31], s56 offen offset:1024  lds
    buffer_load_dwordx4 v12, s[28:31], s56 offen offset:2048  lds
    buffer_load_dwordx4 v13, s[28:31], s56 offen offset:3072  lds
    s_add_u32 s56, s56, 262144
    s_waitcnt vmcnt(10)
    s_barrier
    s_waitcnt vmcnt(4)
    s_barrier
    v_mov_b32 v31, 40960
    s_cmp_lg_u32 s9, 4
    s_cbranch_scc1 L_nv0
    s_waitcnt lgkmcnt(0)
    s_lshr_b32 s60, s70, s2
    s_and_b32 s60, s60, 1
    v_mov_b32 v30, s60
    ds_write_b32 v31, v30
L_nv0:
    s_add_u32 m0, s3, 65536
    s_xor_b32 s60, s59, 16384
    buffer_load_dwordx4 v16, s[36:39], s60 offen offset:0 nt lds
    buffer_load_dwordx4 v16, s[36:39], s60 offen offset:1024 nt lds
    buffer_load_dwordx4 v16, s[36:39], s60 offen offset:2048 nt lds
    buffer_load_dwordx4 v16, s[36:39], s60 offen offset:3072 nt lds
    s_add_u32 m0, s3, 49152
    s_xor_b32 s60, s59, 32768
    buffer_load_dwordx4 v16, s[36:39], s60 offen offset:0 nt lds
    buffer_load_dwordx4 v16, s[36:39], s60 offen offset:1024 nt lds
    buffer_load_dwordx4 v16, s[36:39], s60 offen offset:2048 nt lds
    buffer_load_dwordx4 v16, s[36:39], s60 offen offset:3072 nt lds
    s_waitcnt lgkmcnt(0)
    s_waitcnt vmcnt(8)
    s_barrier
    s_branch L_ltail
L_plan1:
    s_add_u32 m0, s22, 32768
    s_nop 0
    buffer_load_dwordx4 v14, s[24:27], s57 offen offset:0  lds
    buffer_load_dwordx4 v15, s[24:27], s57 offen offset:1024  lds
    s_add_u32 s57, s57, 128
    s_cmp_eq_u32 s57, s62
    s_cselect_b32 s60, 1152, 0
    s_sub_u32 s57, s57, s60
    s_add_u32 m0, s3, 0
    s_nop 0
    buffer_load_dwordx4 v10, s[28:31], s56 offen offset:0  lds
    buffer_load_dwordx4 v11, s[28:31], s56 offen offset:1024  lds
    buffer_load_dwordx4 v12, s[28:31], s56 offen offset:2048  lds
    buffer_load_dwordx4 v13, s[28:31], s56 offen offset:3072  lds
    s_add_u32 s56, s56, 262144
    s_mov_b32 s32, s14
    s_mov_b32 s33, s15
    s_mov_b32 s34, 16777216
    s_mov_b32 s35, 0x20000
    s_mov_b32 s36, s16
    s_mov_b32 s37, s17
    s_mov_b32 s38, 16777216
    s_mov_b32 s39, 0x20000
    s_mov_b32 s40, s20
    s_mov_b32 s41, s21
    s_mov_b32 s42, 4718592
    s_mov_b32 s43, 0x20000
    v_lshl_add_u32 v8, v3, 8, v5
    v_add_u32 v16, s3, v8
    v_xor_b32 v17, 16, v16
    v_xor_b32 v18, 32, v16
    v_xor_b32 v19, 48, v16
    s_lshl_b32 s59, s8, 21
    s_lshl_b32 s60, s7, 17
    s_add_u32 s59, s59, s60
    s_add_u32 s60, s7, s8
    s_and_b32 s60, s60, 7
    s_lshl_b32 s60, s60, 14
    s_or_b32 s59, s59, s60
    s_add_u32 m0, s3, 16384
    s_nop 0
    buffer_load_dwordx4 v10, s[28:31], s56 offen offset:0  lds
    buffer_load_dwordx4 v11, s[28:31], s56 offen offset:1024  lds
    buffer_load_dwordx4 v12, s[28:31], s56 offen offset:2048  lds
    buffer_load_dwordx4 v13, s[28:31], s56 offen offset:3072  lds
    s_add_u32 s56, s56, 262144
    s_cmp_eq_u32 s56, s58
    s_cselect_b32 s60, 4718592, 0
    s_sub_u32 s56, s56, s60
    s_add_u32 m0, s22, 40960
    s_nop 0
    buffer_load_dwordx4 v14, s[24:27], s57 offen offset:0  lds
    buffer_load_dwordx4 v15, s[24:27], s57 offen offset:1024  lds
    s_add_u32 s57, s57, 128
    s_cmp_eq_u32 s57, s62
    s_cselect_b32 s60, 1152, 0
    s_sub_u32 s57, s57, s60
    s_add_u32 m0, s3, 49152
    s_nop 0
    buffer_load_dwordx4 v10, s[28:31], s56 offen offset:0  lds
    buffer_load_dwordx4 v11, s[28:31], s56 offen offset:1024  lds
    buffer_load_dwordx4 v12, s[28:31], s56 offen offset:2048  lds
    buffer_load_dwordx4 v13, s[28:31], s56 offen offset:3072  lds
    s_add_u32 s56, s56, 262144
    v_mov_b32 v31, 65536
    s_cmp_eq_u32 s71, 2
    s_cbranch_scc1 L_find
L_go1:
    s_waitcnt vmcnt(10)
    s_barrier
    s_add_u32 m0, s3, 65536
    s_nop 0
    buffer_load_dwordx4 v10, s[28:31], s56 offen offset:0  lds
    buffer_load_dwordx4 v11, s[28:31], s56 offen offset:1024  lds
    buffer_load_dwordx4 v12, s[28:31], s56 offen offset:2048  lds
    buffer_load_dwordx4 v13, s[28:31], s56 offen offset:3072  lds
    s_add_u32 s56, s56, 262144
    s_cmp_eq_u32 s56, s58
    s_cselect_b32 s60, 4718592, 0
    s_sub_u32 s56, s56, s60
    s_waitcnt vmcnt(10)
    s_barrier
    s_add_u32 m0, s3, 0
    s_nop 0
    buffer_load_dwordx4 v10, s[28:31], s56 offen offset:0  lds
    buffer_load_dwordx4 v11, s[28:31], s56 offen offset:1024  lds
    buffer_load_dwordx4 v12, s[28:31], s56 offen offset:2048  lds
    buffer_load_dwordx4 v13, s[28:31], s56 offen offset:3072  lds
    s_add_u32 s56, s56, 262144
    v_lshrrev_b32 v6, 5, v1
    v_lshl_add_u32 v6, v6, 2, v3
    s_lshl_b32 s60, s10, 5
    v_add_u32 v6, s60, v6
    v_mul_u32_u24 v6, 1152, v6
    v_and_b32 v7, 1, v4
    v_lshlrev_b32 v7, 6, v7
    v_lshl_add_u32 v7, v2, 4, v7
    v_add_u32 v20, v6, v7
    v_add_u32 v21, 8192, v20
    v_add_u32 v22, 16384, v20
    v_add_u32 v23, 24576, v20
    s_mul_i32 s67, s7, 294912
    v_lshlrev_b32 v26, 4, v1
    v_add_u32 v26, s3, v26
    v_add_u32 v27, 98304, v26
    s_mov_b32 s48, s94
    s_mov_b32 s49, s95
    s_mov_b32 s50, 1179648
    s_mov_b32 s51, 0x20000
    s_mov_b32 s52, s96
    s_mov_b32 s53, s97
    s_mov_b32 s54, 256
    s_mov_b32 s55, 0x20000
    s_mov_b32 s44, s98
    s_mov_b32 s45, s99
    s_mov_b32 s46, 18911232
    s_mov_b32 s47, 0x20000
    s_waitcnt vmcnt(8)
    s_barrier
    s_add_u32 m0, s22, 32768
    s_nop 0
    buffer_load_dwordx4 v14, s[24:27], s57 offen offset:0  lds
    buffer_load_dwordx4 v15, s[24:27], s57 offen offset:1024  lds
    s_add_u32 s57, s57, 128
    s_cmp_eq_u32 s57, s62
    s_cselect_b32 s60, 1152, 0
    s_sub_u32 s57, s57, s60
    s_add_u32 m0, s3, 16384
    s_nop 0
    buffer_load_dwordx4 v10, s[28:31], s56 offen offset:0  lds
    buffer_load_dwordx4 v11, s[28:31], s56 offen offset:1024  lds
    buffer_load_dwordx4 v12, s[28:31], s56 offen offset:2048  lds
    buffer_load_dwordx4 v13, s[28:31], s56 offen offset:3072  lds
    s_add_u32 s56, s56, 262144
    s_cmp_eq_u32 s56, s58
    s_cselect_b32 s60, 4718592, 0
    s_sub_u32 s56, s56, s60
    s_waitcnt vmcnt(10)
    s_barrier
    s_add_u32 m0, s3, 49152
    s_nop 0
    buffer_load_dwordx4 v10, s[28:31], s56 offen offset:0  lds
    buffer_load_dwordx4 v11, s[28:31], s56 offen offset:1024  lds
    buffer_load_dwordx4 v12, s[28:31], s56 offen offset:2048  lds
    buffer_load_dwordx4 v13, s[28:31], s56 offen offset:3072  lds
    s_add_u32 s56, s56, 262144
    s_waitcnt vmcnt(8)
    s_barrier
    s_add_u32 m0, s22, 40960
    s_nop 0
    buffer_load_dwordx4 v14, s[24:27], s57 offen offset:0  lds
    buffer_load_dwordx4 v15, s[24:27], s57 offen offset:1024  lds
    s_add_u32 s57, s57, 128
    s_cmp_eq_u32 s57, s62
    s_cselect_b32 s60, 1152, 0
    s_sub_u32 s57, s57, s60
    s_add_u32 m0, s3, 65536
    s_nop 0
    buffer_load_dwordx4 v10, s[28:31], s56 offen offset:0  lds
    buffer_load_dwordx4 v11, s[28:31], s56 offen offset:1024  lds
    buffer_load_dwordx4 v12, s[28:31], s56 offen offset:2048  lds
    buffer_load_dwordx4 v13, s[28:31], s56 offen offset:3072  lds
    s_add_u32 s56, s56, 262144
    s_cmp_eq_u32 s56, s58
    s_cselect_b32 s60, 4718592, 0
    s_sub_u32 s56, s56, s60
    s_waitcnt vmcnt(10)
    s_barrier
    s_add_u32 m0, s3, 0
    s_nop 0
    buffer_load_dwordx4 v10, s[28:31], s56 offen offset:0  lds
    buffer_load_dwordx4 v11, s[28:31], s56 offen offset:1024  lds
    buffer_load_dwordx4 v12, s[28:31], s56 offen offset:2048  lds
    buffer_load_dwordx4 v13, s[28:31], s56 offen offset:3072  lds
    s_add_u32 s56, s56, 262144
    s_add_u32 m0, s3, 131072
    s_xor_b32 s60, s59, 0
    buffer_load_dwordx4 v16, s[32:35], s60 offen offset:0 nt lds
    buffer_load_dwordx4 v17, s[32:35], s60 offen offset:1024 nt lds
    buffer_load_dwordx4 v18, s[32:35], s60 offen offset:2048 nt lds
    buffer_load_dwordx4 v19, s[32:35], s60 offen offset:3072 nt lds
    s_add_u32 m0, s3, 147456
    s_xor_b32 s60, s59, 16384
    buffer_load_dwordx4 v16, s[32:35], s60 offen offset:0 nt lds
    buffer_load_dwordx4 v17, s[32:35], s60 offen offset:1024 nt lds
    buffer_load_dwordx4 v18, s[32:35], s60 offen offset:2048 nt lds
    buffer_load_dwordx4 v19, s[32:35], s60 offen offset:3072 nt lds
    s_add_u32 m0, s3, 81920
    s_xor_b32 s60, s59, 0
    buffer_load_dwordx4 v16, s[36:39], s60 offen offset:0 nt lds
    buffer_load_dwordx4 v16, s[36:39], s60 offen offset:1024 nt lds
    buffer_load_dwordx4 v16, s[36:39], s60 offen offset:2048 nt lds
    buffer_load_dwordx4 v16, s[36:39], s60 offen offset:3072 nt lds
    s_add_u32 m0, s3, 98304
    s_xor_b32 s60, s59, 32768
    buffer_load_dwordx4 v16, s[32:35], s60 offen offset:0 nt lds
    buffer_load_dwordx4 v17, s[32:35], s60 offen offset:1024 nt lds
    buffer_load_dwordx4 v18, s[32:35], s60 offen offset:2048 nt lds
    buffer_load_dwordx4 v19, s[32:35], s60 offen offset:3072 nt lds
    s_add_u32 m0, s3, 114688
    s_xor_b32 s60, s59, 49152
    buffer_load_dwordx4 v16, s[32:35], s60 offen offset:0 nt lds
    buffer_load_dwordx4 v17, s[32:35], s60 offen offset:1024 nt lds
    buffer_load_dwordx4 v18, s[32:35], s60 offen offset:2048 nt lds
    buffer_load_dwordx4 v19, s[32:35], s60 offen offset:3072 nt lds
    s_waitcnt vmcnt(28)
    s_barrier
    s_add_u32 m0, s22, 32768
    s_nop 0
    buffer_load_dwordx4 v14, s[24:27], s57 offen offset:0  lds
    buffer_load_dwordx4 v15, s[24:27], s57 offen offset:1024  lds
    s_add_u32 s57, s57, 128
    s_cmp_eq_u32 s57, s62
    s_cselect_b32 s60, 1152, 0
    s_sub_u32 s57, s57, s60
    s_add_u32 m0, s3, 16384
    s_nop 0
    buffer_load_dwordx4 v10, s[28:31], s56 offen offset:0  lds
    buffer_load_dwordx4 v11, s[28:31], s56 offen offset:1024  lds
    buffer_load_dwordx4 v12, s[28:31], s56 offen offset:2048  lds
    buffer_load_dwordx4 v13, s[28:31], s56 offen offset:3072  lds
    s_add_u32 s56, s56, 262144
    s_cmp_eq_u32 s56, s58
    s_cselect_b32 s60, 4718592, 0
    s_sub_u32 s56, s56, s60
    s_waitcnt vmcnt(30)
    s_barrier
    s_add_u32 m0, s3, 49152
    s_nop 0
    buffer_load_dwordx4 v10, s[28:31], s56 offen offset:0  lds
    buffer_load_dwordx4 v11, s[28:31], s56 offen offset:1024  lds
    buffer_load_dwordx4 v12, s[28:31], s56 offen offset:2048  lds
    buffer_load_dwordx4 v13, s[28:31], s56 offen offset:3072  lds
    s_add_u32 s56, s56, 262144
    s_waitcnt vmcnt(8)
    s_barrier
    s_add_u32 m0, s22, 40960
    s_nop 0
    buffer_load_dwordx4 v14, s[24:27], s57 offen offset:0  lds
    buffer_load_dwordx4 v15, s[24:27], s57 offen offset:1024  lds
    s_add_u32 s57, s57, 128
    s_cmp_eq_u32 s57, s62
    s_cselect_b32 s60, 1152, 0
    s_sub_u32 s57, s57, s60
    s_add_u32 m0, s3, 65536
    s_nop 0
    buffer_load_dwordx4 v10, s[28:31], s56 offen offset:0  lds
    buffer_load_dwordx4 v11, s[28:31], s56 offen offset:1024  lds
    buffer_load_dwordx4 v12, s[28:31], s56 offen offset:2048  lds
    buffer_load_dwordx4 v13, s[28:31], s56 offen offset:3072  lds
    s_add_u32 s56, s56, 262144
    s_cmp_eq_u32 s56, s58
    s_cselect_b32 s60, 4718592, 0
    s_sub_u32 s56, s56, s60
    s_waitcnt vmcnt(10)
    s_barrier
    s_add_u32 m0, s3, 0
    s_nop 0
    buffer_load_dwordx4 v10, s[28:31], s56 offen offset:0  lds
    buffer_load_dwordx4 v11, s[28:31], s56 offen offset:1024  lds
    buffer_load_dwordx4 v12, s[28:31], s56 offen offset:2048  lds
    buffer_load_dwordx4 v13, s[28:31], s56 offen offset:3072  lds
    s_add_u32 s56, s56, 262144
    s_waitcnt vmcnt(8)
    s_barrier
    s_add_u32 m0, s22, 32768
    s_nop 0
    buffer_load_dwordx4 v14, s[24:27], s57 offen offset:0  lds
    buffer_load_dwordx4 v15, s[24:27], s57 offen offset:1024  lds
    s_add_u32 s57, s57, 128
    s_cmp_eq_u32 s57, s62
    s_cselect_b32 s60, 1152, 0
    s_sub_u32 s57, s57, s60
    s_add_u32 m0, s3, 16384
    s_nop 0
    buffer_load_dwordx4 v10, s[28:31], s56 offen offset:0  lds
    buffer_load_dwordx4 v11, s[28:31], s56 offen offset:1024  lds
    buffer_load_dwordx4 v12, s[28:31], s56 offen offset:2048  lds
    buffer_load_dwordx4 v13, s[28:31], s56 offen offset:3072  lds
    s_add_u32 s56, s56, 262144
    s_cmp_eq_u32 s56, s58
    s_cselect_b32 s60, 4718592, 0
    s_sub_u32 s56, s56, s60
    s_waitcnt vmcnt(10)
    s_barrier
    s_add_u32 m0, s3, 49152
    s_nop 0
    buffer_load_dwordx4 v10, s[28:31], s56 offen offset:0  lds
    buffer_load_dwordx4 v11, s[28:31], s56 offen offset:1024  lds
    buffer_load_dwordx4 v12, s[28:31], s56 offen offset:2048  lds
    buffer_load_dwordx4 v13, s[28:31], s56 offen offset:3072  lds
    s_add_u32 s56, s56, 262144
    s_waitcnt vmcnt(8)
    s_barrier
    s_add_u32 m0, s22, 40960
    s_nop 0
    buffer_load_dwordx4 v14, s[24:27], s57 offen offset:0  lds
    buffer_load_dwordx4 v15, s[24:27], s57 offen offset:1024  lds
    s_add_u32 s57, s57, 128
    s_cmp_eq_u32 s57, s62
    s_cselect_b32 s60, 1152, 0
    s_sub_u32 s57, s57, s60
    s_add_u32 m0, s3, 65536
    s_nop 0
    buffer_load_dwordx4 v10, s[28:31], s56 offen offset:0  lds
    buffer_load_dwordx4 v11, s[28:31], s56 offen offset:1024  lds
    buffer_load_dwordx4 v12, s[28:31], s56 offen offset:2048  lds
    buffer_load_dwordx4 v13, s[28:31], s56 offen offset:3072  lds
    s_add_u32 s56, s56, 262144
    s_cmp_eq_u32 s56, s58
    s_cselect_b32 s60, 4718592, 0
    s_sub_u32 s56, s56, s60
    s_waitcnt vmcnt(10)
    s_barrier
    s_add_u32 m0, s3, 0
    s_nop 0
    buffer_load_dwordx4 v10, s[28:31], s56 offen offset:0  lds
    buffer_load_dwordx4 v11, s[28:31], s56 offen offset:1024  lds
    buffer_load_dwordx4 v12, s[28:31], s56 offen offset:2048  lds
    buffer_load_dwordx4 v13, s[28:31], s56 offen offset:3072  lds
    s_add_u32 s56, s56, 262144
    s_waitcnt vmcnt(8)
    s_barrier
    s_add_u32 m0, s22, 32768
    s_nop 0
    buffer_load_dwordx4 v14, s[24:27], s57 offen offset:0  lds
    buffer_load_dwordx4 v15, s[24:27], s57 offen offset:1024  lds
    s_add_u32 m0, s3, 16384
    s_nop 0
    buffer_load_dwordx4 v10, s[28:31], s56 offen offset:0  lds
    buffer_load_dwordx4 v11, s[28:31], s56 offen offset:1024  lds
    buffer_load_dwordx4 v12, s[28:31], s56 offen offset:2048  lds
    buffer_load_dwordx4 v13, s[28:31], s56 offen offset:3072  lds
    s_add_u32 s56, s56, 262144
    s_waitcnt vmcnt(10)
    s_barrier
    s_waitcnt vmcnt(4)
    s_barrier
    v_mov_b32 v31, 40960
    s_cmp_lg_u32 s9, 4
    s_cbranch_scc1 L_nv1
    s_waitcnt lgkmcnt(0)
    s_lshr_b32 s60, s70, s2
    s_and_b32 s60, s60, 1
    v_mov_b32 v30, s60
    ds_write_b32 v31, v30
L_nv1:
    s_add_u32 m0, s3, 65536
    s_xor_b32 s60, s59, 16384
    buffer_load_dwordx4 v16, s[36:39], s60 offen offset:0 nt lds
    buffer_load_dwordx4 v16, s[36:39], s60 offen offset:1024 nt lds
    buffer_load_dwordx4 v16, s[36:39], s60 offen offset:2048 nt lds
    buffer_load_dwordx4 v16, s[36:39], s60 offen offset:3072 nt lds
    s_add_u32 m0, s3, 49152
    s_xor_b32 s60, s59, 32768
    buffer_load_dwordx4 v16, s[36:39], s60 offen offset:0 nt lds
    buffer_load_dwordx4 v16, s[36:39], s60 offen offset:1024 nt lds
    buffer_load_dwordx4 v16, s[36:39], s60 offen offset:2048 nt lds
    buffer_load_dwordx4 v16, s[36:39], s60 offen offset:3072 nt lds
    s_waitcnt lgkmcnt(0)
    s_waitcnt vmcnt(8)
    s_barrier
    s_branch L_ltail
L_plan2:
    s_add_u32 m0, s22, 32768
    s_nop 0
    buffer_load_dwordx4 v14, s[24:27], s57 offen offset:0  lds
    buffer_load_dwordx4 v15, s[24:27], s57 offen offset:1024  lds
    s_add_u32 s57, s57, 128
    s_cmp_eq_u32 s57, s62
    s_cselect_b32 s60, 1152, 0
    s_sub_u32 s57, s57, s60
    s_add_u32 m0, s3, 0
    s_nop 0
    buffer_load_dwordx4 v10, s[28:31], s56 offen offset:0  lds
    buffer_load_dwordx4 v11, s[28:31], s56 offen offset:1024  lds
    buffer_load_dwordx4 v12, s[28:31], s56 offen offset:2048  lds
    buffer_load_dwordx4 v13, s[28:31], s56 offen offset:3072  lds
    s_add_u32 s56, s56, 262144
    s_mov_b32 s32, s14
    s_mov_b32 s33, s15
    s_mov_b32 s34, 16777216
    s_mov_b32 s35, 0x20000
    s_mov_b32 s36, s16
    s_mov_b32 s37, s17
    s_mov_b32 s38, 16777216
    s_mov_b32 s39, 0x20000
    s_mov_b32 s40, s20
    s_mov_b32 s41, s21
    s_mov_b32 s42, 4718592
    s_mov_b32 s43, 0x20000
    v_lshl_add_u32 v8, v3, 8, v5
    v_add_u32 v16, s3, v8
    v_xor_b32 v17, 16, v16
    v_xor_b32 v18, 32, v16
    v_xor_b32 v19, 48, v16
    s_lshl_b32 s59, s8, 21
    s_lshl_b32 s60, s7, 17
    s_add_u32 s59, s59, s60
    s_add_u32 s60, s7, s8
    s_and_b32 s60, s60, 7
    s_lshl_b32 s60, s60, 14
    s_or_b32 s59, s59, s60
    s_add_u32 m0, s3, 16384
    s_nop 0
    buffer_load_dwordx4 v10, s[28:31], s56 offen offset:0  lds
    buffer_load_dwordx4 v11, s[28:31], s56 offen offset:1024  lds
    buffer_load_dwordx4 v12, s[28:31], s56 offen offset:2048  lds
    buffer_load_dwordx4 v13, s[28:31], s56 offen offset:3072  lds
    s_add_u32 s56, s56, 262144
    s_cmp_eq_u32 s56, s58
    s_cselect_b32 s60, 4718592, 0
    s_sub_u32 s56, s56, s60
    s_add_u32 m0, s22, 40960
    s_nop 0
    buffer_load_dwordx4 v14, s[24:27], s57 offen offset:0  lds
    buffer_load_dwordx4 v15, s[24:27], s57 offen offset:1024  lds
    s_add_u32 s57, s57, 128
    s_cmp_eq_u32 s57, s62
    s_cselect_b32 s60, 1152, 0
    s_sub_u32 s57, s57, s60
    s_add_u32 m0, s3, 49152
    s_nop 0
    buffer_load_dwordx4 v10, s[28:31], s56 offen offset:0  lds
    buffer_load_dwordx4 v11, s[28:31], s56 offen offset:1024  lds
    buffer_load_dwordx4 v12, s[28:31], s56 offen offset:2048  lds
    buffer_load_dwordx4 v13, s[28:31], s56 offen offset:3072  lds
    s_add_u32 s56, s56, 262144
    v_mov_b32 v31, 65536
    s_cmp_eq_u32 s71, 2
    s_cbranch_scc1 L_find
L_go2:
    s_waitcnt vmcnt(10)
    s_barrier
    s_add_u32 m0, s3, 65536
    s_nop 0
    buffer_load_dwordx4 v10, s[28:31], s56 offen offset:0  lds
    buffer_load_dwordx4 v11, s[28:31], s56 offen offset:1024  lds
    buffer_load_dwordx4 v12, s[28:31], s56 offen offset:2048  lds
    buffer_load_dwordx4 v13, s[28:31], s56 offen offset:3072  lds
    s_add_u32 s56, s56, 262144
    s_cmp_eq_u32 s56, s58
    s_cselect_b32 s60, 4718592, 0
    s_sub_u32 s56, s56, s60
    s_waitcnt vmcnt(10)
    s_barrier
    s_add_u32 m0, s3, 0
    s_nop 0
    buffer_load_dwordx4 v10, s[28:31], s56 offen offset:0  lds
    buffer_load_dwordx4 v11, s[28:31], s56 offen offset:1024  lds
    buffer_load_dwordx4 v12, s[28:31], s56 offen offset:2048  lds
    buffer_load_dwordx4 v13, s[28:31], s56 offen offset:3072  lds
    s_add_u32 s56, s56, 262144
    v_lshrrev_b32 v6, 5, v1
    v_lshl_add_u32 v6, v6, 2, v3
    s_lshl_b32 s60, s10, 5
    v_add_u32 v6, s60, v6
    v_mul_u32_u24 v6, 1152, v6
    v_and_b32 v7, 1, v4
    v_lshlrev_b32 v7, 6, v7
    v_lshl_add_u32 v7, v2, 4, v7
    v_add_u32 v20, v6, v7
    v_add_u32 v21, 8192, v20
    v_add_u32 v22, 16384, v20
    v_add_u32 v23, 24576, v20
    s_mul_i32 s67, s7, 294912
    v_lshlrev_b32 v26, 4, v1
    v_add_u32 v26, s3, v26
    v_add_u32 v27, 98304, v26
    s_mov_b32 s48, s94
    s_mov_b32 s49, s95
    s_mov_b32 s50, 1179648
    s_mov_b32 s51, 0x20000
    s_mov_b32 s52, s96
    s_mov_b32 s53, s97
    s_mov_b32 s54, 256
    s_mov_b32 s55, 0x20000
    s_mov_b32 s44, s98
    s_mov_b32 s45, s99
    s_mov_b32 s46, 18911232
    s_mov_b32 s47, 0x20000
    s_waitcnt vmcnt(8)
    s_barrier
    s_add_u32 m0, s22, 32768
    s_nop 0
    buffer_load_dwordx4 v14, s[24:27], s57 offen offset:0  lds
    buffer_load_dwordx4 v15, s[24:27], s57 offen offset:1024  lds
    s_add_u32 s57, s57, 128
    s_cmp_eq_u32 s57, s62
    s_cselect_b32 s60, 1152, 0
    s_sub_u32 s57, s57, s60
    s_add_u32 m0, s3, 16384
    s_nop 0
    buffer_load_dwordx4 v10, s[28:31], s56 offen offset:0  lds
    buffer_load_dwordx4 v11, s[28:31], s56 offen offset:1024  lds
    buffer_load_dwordx4 v12, s[28:31], s56 offen offset:2048  lds
    buffer_load_dwordx4 v13, s[28:31], s56 offen offset:3072  lds
    s_add_u32 s56, s56, 262144
    s_cmp_eq_u32 s56, s58
    s_cselect_b32 s60, 4718592, 0
    s_sub_u32 s56, s56, s60
    s_waitcnt vmcnt(10)
    s_barrier
    s_add_u32 m0, s3, 49152
    s_nop 0
    buffer_load_dwordx4 v10, s[28:31], s56 offen offset:0  lds
    buffer_load_dwordx4 v11, s[28:31], s56 offen offset:1024  lds
    buffer_load_dwordx4 v12, s[28:31], s56 offen offset:2048  lds
    buffer_load_dwordx4 v13, s[28:31], s56 offen offset:3072  lds
    s_add_u32 s56, s56, 262144
    s_waitcnt vmcnt(8)
    s_barrier
    s_add_u32 m0, s22, 40960
    s_nop 0
    buffer_load_dwordx4 v14, s[24:27], s57 offen offset:0  lds
    buffer_load_dwordx4 v15, s[24:27], s57 offen offset:1024  lds
    s_add_u32 s57, s57, 128
    s_cmp_eq_u32 s57, s62
    s_cselect_b32 s60, 1152, 0
    s_sub_u32 s57, s57, s60
    s_add_u32 m0, s3, 65536
    s_nop 0
    buffer_load_dwordx4 v10, s[28:31], s56 offen offset:0  lds
    buffer_load_dwordx4 v11, s[28:31], s56 offen offset:1024  lds
    buffer_load_dwordx4 v12, s[28:31], s56 offen offset:2048  lds
    buffer_load_dwordx4 v13, s[28:31], s56 offen offset:3072  lds
    s_add_u32 s56, s56, 262144
    s_cmp_eq_u32 s56, s58
    s_cselect_b32 s60, 4718592, 0
    s_sub_u32 s56, s56, s60
    s_waitcnt vmcnt(10)
    s_barrier
    s_add_u32 m0, s3, 0
    s_nop 0
    buffer_load_dwordx4 v10, s[28:31], s56 offen offset:0  lds
    buffer_load_dwordx4 v11, s[28:31], s56 offen offset:1024  lds
    buffer_load_dwordx4 v12, s[28:31], s56 offen offset:2048  lds
    buffer_load_dwordx4 v13, s[28:31], s56 offen offset:3072  lds
    s_add_u32 s56, s56, 262144
    s_waitcnt vmcnt(8)
    s_barrier
    s_add_u32 m0, s22, 32768
    s_nop 0
    buffer_load_dwordx4 v14, s[24:27], s57 offen offset:0  lds
    buffer_load_dwordx4 v15, s[24:27], s57 offen offset:1024  lds
    s_add_u32 s57, s57, 128
    s_cmp_eq_u32 s57, s62
    s_cselect_b32 s60, 1152, 0
    s_sub_u32 s57, s57, s60
    s_add_u32 m0, s3, 16384
    s_nop 0
    buffer_load_dwordx4 v10, s[28:31], s56 offen offset:0  lds
    buffer_load_dwordx4 v11, s[28:31], s56 offen offset:1024  lds
    buffer_load_dwordx4 v12, s[28:31], s56 offen offset:2048  lds
    buffer_load_dwordx4 v13, s[28:31], s56 offen offset:3072  lds
    s_add_u32 s56, s56, 262144
    s_cmp_eq_u32 s56, s58
    s_cselect_b32 s60, 4718592, 0
    s_sub_u32 s56, s56, s60
    s_waitcnt vmcnt(10)
    s_barrier
    s_add_u32 m0, s3, 49152
    s_nop 0
    buffer_load_dwordx4 v10, s[28:31], s56 offen offset:0  lds
    buffer_load_dwordx4 v11, s[28:31], s56 offen offset:1024  lds
    buffer_load_dwordx4 v12, s[28:31], s56 offen offset:2048  lds
    buffer_load_dwordx4 v13, s[28:31], s56 offen offset:3072  lds
    s_add_u32 s56, s56, 262144
    s_waitcnt vmcnt(8)
    s_barrier
    s_add_u32 m0, s22, 40960
    s_nop 0
    buffer_load_dwordx4 v14, s[24:27], s57 offen offset:0  lds
    buffer_load_dwordx4 v15, s[24:27], s57 offen offset:1024  lds
    s_add_u32 s57, s57, 128
    s_cmp_eq_u32 s57, s62
    s_cselect_b32 s60, 1152, 0
    s_sub_u32 s57, s57, s60
    s_add_u32 m0, s3, 65536
    s_nop 0
    buffer_load_dwordx4 v10, s[28:31], s56 offen offset:0  lds
    buffer_load_dwordx4 v11, s[28:31], s56 offen offset:1024  lds
    buffer_load_dwordx4 v12, s[28:31], s56 offen offset:2048  lds
    buffer_load_dwordx4 v13, s[28:31], s56 offen offset:3072  lds
    s_add_u32 s56, s56, 262144
    s_cmp_eq_u32 s56, s58
    s_cselect_b32 s60, 4718592, 0
    s_sub_u32 s56, s56, s60
    s_waitcnt vmcnt(10)
    s_barrier
    s_add_u32 m0, s3, 0
    s_nop 0
    buffer_load_dwordx4 v10, s[28:31], s56 offen offset:0  lds
    buffer_load_dwordx4 v11, s[28:31], s56 offen offset:1024  lds
    buffer_load_dwordx4 v12, s[28:31], s56 offen offset:2048  lds
    buffer_load_dwordx4 v13, s[28:31], s56 offen offset:3072  lds
    s_add_u32 s56, s56, 262144
    s_add_u32 m0, s3, 131072
    s_xor_b32 s60, s59, 0
    buffer_load_dwordx4 v16, s[32:35], s60 offen offset:0 nt lds
    buffer_load_dwordx4 v17, s[32:35], s60 offen offset:1024 nt lds
    buffer_load_dwordx4 v18, s[32:35], s60 offen offset:2048 nt lds
    buffer_load_dwordx4 v19, s[32:35], s60 offen offset:3072 nt lds
    s_add_u32 m0, s3, 147456
    s_xor_b32 s60, s59, 16384
    buffer_load_dwordx4 v16, s[32:35], s60 offen offset:0 nt lds
    buffer_load_dwordx4 v17, s[32:35], s60 offen offset:1024 nt lds
    buffer_load_dwordx4 v18, s[32:35], s60 offen offset:2048 nt lds
    buffer_load_dwordx4 v19, s[32:35], s60 offen offset:3072 nt lds
    s_add_u32 m0, s3, 81920
    s_xor_b32 s60, s59, 0
    buffer_load_dwordx4 v16, s[36:39], s60 offen offset:0 nt lds
    buffer_load_dwordx4 v16, s[36:39], s60 offen offset:1024 nt lds
    buffer_load_dwordx4 v16, s[36:39], s60 offen offset:2048 nt lds
    buffer_load_dwordx4 v16, s[36:39], s60 offen offset:3072 nt lds
    s_add_u32 m0, s3, 98304
    s_xor_b32 s60, s59, 32768
    buffer_load_dwordx4 v16, s[32:35], s60 offen offset:0 nt lds
    buffer_load_dwordx4 v17, s[32:35], s60 offen offset:1024 nt lds
    buffer_load_dwordx4 v18, s[32:35], s60 offen offset:2048 nt lds
    buffer_load_dwordx4 v19, s[32:35], s60 offen offset:3072 nt lds
    s_add_u32 m0, s3, 114688
    s_xor_b32 s60, s59, 49152
    buffer_load_dwordx4 v16, s[32:35], s60 offen offset:0 nt lds
    buffer_load_dwordx4 v17, s[32:35], s60 offen offset:1024 nt lds
    buffer_load_dwordx4 v18, s[32:35], s60 offen offset:2048 nt lds
    buffer_load_dwordx4 v19, s[32:35], s60 offen offset:3072 nt lds
    s_waitcnt vmcnt(28)
    s_barrier
    s_add_u32 m0, s22, 32768
    s_nop 0
    buffer_load_dwordx4 v14, s[24:27], s57 offen offset:0  lds
    buffer_load_dwordx4 v15, s[24:27], s57 offen offset:1024  lds
    s_add_u32 s57, s57, 128
    s_cmp_eq_u32 s57, s62
    s_cselect_b32 s60, 1152, 0
    s_sub_u32 s57, s57, s60
    s_add_u32 m0, s3, 16384
    s_nop 0
    buffer_load_dwordx4 v10, s[28:31], s56 offen offset:0  lds
    buffer_load_dwordx4 v11, s[28:31], s56 offen offset:1024  lds
    buffer_load_dwordx4 v12, s[28:31], s56 offen offset:2048  lds
    buffer_load_dwordx4 v13, s[28:31], s56 offen offset:3072  lds
    s_add_u32 s56, s56, 262144
    s_cmp_eq_u32 s56, s58
    s_cselect_b32 s60, 4718592, 0
    s_sub_u32 s56, s56, s60
    s_waitcnt vmcnt(30)
    s_barrier
    s_add_u32 m0, s3, 49152
    s_nop 0
    buffer_load_dwordx4 v10, s[28:31], s56 offen offset:0  lds
    buffer_load_dwordx4 v11, s[28:31], s56 offen offset:1024  lds
    buffer_load_dwordx4 v12, s[28:31], s56 offen offset:2048  lds
    buffer_load_dwordx4 v13, s[28:31], s56 offen offset:3072  lds
    s_add_u32 s56, s56, 262144
    s_waitcnt vmcnt(8)
    s_barrier
    s_add_u32 m0, s22, 40960
    s_nop 0
    buffer_load_dwordx4 v14, s[24:27], s57 offen offset:0  lds
    buffer_load_dwordx4 v15, s[24:27], s57 offen offset:1024  lds
    s_add_u32 s57, s57, 128
    s_cmp_eq_u32 s57, s62
    s_cselect_b32 s60, 1152, 0
    s_sub_u32 s57, s57, s60
    s_add_u32 m0, s3, 65536
    s_nop 0
    buffer_load_dwordx4 v10, s[28:31], s56 offen offset:0  lds
    buffer_load_dwordx4 v11, s[28:31], s56 offen offset:1024  lds
    buffer_load_dwordx4 v12, s[28:31], s56 offen offset:2048  lds
    buffer_load_dwordx4 v13, s[28:31], s56 offen offset:3072  lds
    s_add_u32 s56, s56, 262144
    s_cmp_eq_u32 s56, s58
    s_cselect_b32 s60, 4718592, 0
    s_sub_u32 s56, s56, s60
    s_waitcnt vmcnt(10)
    s_barrier
    s_add_u32 m0, s3, 0
    s_nop 0
    buffer_load_dwordx4 v10, s[28:31], s56 offen offset:0  lds
    buffer_load_dwordx4 v11, s[28:31], s56 offen offset:1024  lds
    buffer_load_dwordx4 v12, s[28:31], s56 offen offset:2048  lds
    buffer_load_dwordx4 v13, s[28:31], s56 offen offset:3072  lds
    s_add_u32 s56, s56, 262144
    s_waitcnt vmcnt(8)
    s_barrier
    s_add_u32 m0, s22, 32768
    s_nop 0
    buffer_load_dwordx4 v14, s[24:27], s57 offen offset:0  lds
    buffer_load_dwordx4 v15, s[24:27], s57 offen offset:1024  lds
    s_add_u32 m0, s3, 16384
    s_nop 0
    buffer_load_dwordx4 v10, s[28:31], s56 offen offset:0  lds
    buffer_load_dwordx4 v11, s[28:31], s56 offen offset:1024  lds
    buffer_load_dwordx4 v12, s[28:31], s56 offen offset:2048  lds
    buffer_load_dwordx4 v13, s[28:31], s56 offen offset:3072  lds
    s_add_u32 s56, s56, 262144
    s_waitcnt vmcnt(10)
    s_barrier
    s_waitcnt vmcnt(4)
    s_barrier
    v_mov_b32 v31, 40960
    s_cmp_lg_u32 s9, 4
    s_cbranch_scc1 L_nv2
    s_waitcnt lgkmcnt(0)
    s_lshr_b32 s60, s70, s2
    s_and_b32 s60, s60, 1
    v_mov_b32 v30, s60
    ds_write_b32 v31, v30
L_nv2:
    s_add_u32 m0, s3, 65536
    s_xor_b32 s60, s59, 16384
    buffer_load_dwordx4 v16, s[36:39], s60 offen offset:0 nt lds
    buffer_load_dwordx4 v16, s[36:39], s60 offen offset:1024 nt lds
    buffer_load_dwordx4 v16, s[36:39], s60 offen offset:2048 nt lds
    buffer_load_dwordx4 v16, s[36:39], s60 offen offset:3072 nt lds
    s_add_u32 m0, s3, 49152
    s_xor_b32 s60, s59, 32768
    buffer_load_dwordx4 v16, s[36:39], s60 offen offset:0 nt lds
    buffer_load_dwordx4 v16, s[36:39], s60 offen offset:1024 nt lds
    buffer_load_dwordx4 v16, s[36:39], s60 offen offset:2048 nt lds
    buffer_load_dwordx4 v16, s[36:39], s60 offen offset:3072 nt lds
    s_waitcnt lgkmcnt(0)
    s_waitcnt vmcnt(8)
    s_barrier
    s_branch L_ltail
L_plan3:
    s_add_u32 m0, s22, 32768
    s_nop 0
    buffer_load_dwordx4 v14, s[24:27], s57 offen offset:0  lds
    buffer_load_dwordx4 v15, s[24:27], s57 offen offset:1024  lds
    s_add_u32 s57, s57, 128
    s_cmp_eq_u32 s57, s62
    s_cselect_b32 s60, 1152, 0
    s_sub_u32 s57, s57, s60
    s_add_u32 m0, s3, 0
    s_nop 0
    buffer_load_dwordx4 v10, s[28:31], s56 offen offset:0  lds
    buffer_load_dwordx4 v11, s[28:31], s56 offen offset:1024  lds
    buffer_load_dwordx4 v12, s[28:31], s56 offen offset:2048  lds
    buffer_load_dwordx4 v13, s[28:31], s56 offen offset:3072  lds
    s_add_u32 s56, s56, 262144
    s_mov_b32 s32, s14
    s_mov_b32 s33, s15
    s_mov_b32 s34, 16777216
    s_mov_b32 s35, 0x20000
    s_mov_b32 s36, s16
    s_mov_b32 s37, s17
    s_mov_b32 s38, 16777216
    s_mov_b32 s39, 0x20000
    s_mov_b32 s40, s20
    s_mov_b32 s41, s21
    s_mov_b32 s42, 4718592
    s_mov_b32 s43, 0x20000
    v_lshl_add_u32 v8, v3, 8, v5
    v_add_u32 v16, s3, v8
    v_xor_b32 v17, 16, v16
    v_xor_b32 v18, 32, v16
    v_xor_b32 v19, 48, v16
    s_lshl_b32 s59, s8, 21
    s_lshl_b32 s60, s7, 17
    s_add_u32 s59, s59, s60
    s_add_u32 s60, s7, s8
    s_and_b32 s60, s60, 7
    s_lshl_b32 s60, s60, 14
    s_or_b32 s59, s59, s60
    s_add_u32 m0, s3, 16384
    s_nop 0
    buffer_load_dwordx4 v10, s[28:31], s56 offen offset:0  lds
    buffer_load_dwordx4 v11, s[28:31], s56 offen offset:1024  lds
    buffer_load_dwordx4 v12, s[28:31], s56 offen offset:2048  lds
    buffer_load_dwordx4 v13, s[28:31], s56 offen offset:3072  lds
    s_add_u32 s56, s56, 262144
    s_cmp_eq_u32 s56, s58
    s_cselect_b32 s60, 4718592, 0
    s_sub_u32 s56, s56, s60
    s_add_u32 m0, s22, 40960
    s_nop 0
    buffer_load_dwordx4 v14, s[24:27], s57 offen offset:0  lds
    buffer_load_dwordx4 v15, s[24:27], s57 offen offset:1024  lds
    s_add_u32 s57, s57, 128
    s_cmp_eq_u32 s57, s62
    s_cselect_b32 s60, 1152, 0
    s_sub_u32 s57, s57, s60
    s_add_u32 m0, s3, 49152
    s_nop 0
    buffer_load_dwordx4 v10, s[28:31], s56 offen offset:0  lds
    buffer_load_dwordx4 v11, s[28:31], s56 offen offset:1024  lds
    buffer_load_dwordx4 v12, s[28:31], s56 offen offset:2048  lds
    buffer_load_dwordx4 v13, s[28:31], s56 offen offset:3072  lds
    s_add_u32 s56, s56, 262144
    v_mov_b32 v31, 65536
    s_cmp_eq_u32 s71, 2
    s_cbranch_scc1 L_find
L_go3:
    s_waitcnt vmcnt(10)
    s_barrier
    s_add_u32 m0, s3, 65536
    s_nop 0
    buffer_load_dwordx4 v10, s[28:31], s56 offen offset:0  lds
    buffer_load_dwordx4 v11, s[28:31], s56 offen offset:1024  lds
    buffer_load_dwordx4 v12, s[28:31], s56 offen offset:2048  lds
    buffer_load_dwordx4 v13, s[28:31], s56 offen offset:3072  lds
    s_add_u32 s56, s56, 262144
    s_cmp_eq_u32 s56, s58
    s_cselect_b32 s60, 4718592, 0
    s_sub_u32 s56, s56, s60
    s_waitcnt vmcnt(10)
    s_barrier
    s_add_u32 m0, s3, 0
    s_nop 0
    buffer_load_dwordx4 v10, s[28:31], s56 offen offset:0  lds
    buffer_load_dwordx4 v11, s[28:31], s56 offen offset:1024  lds
    buffer_load_dwordx4 v12, s[28:31], s56 offen offset:2048  lds
    buffer_load_dwordx4 v13, s[28:31], s56 offen offset:3072  lds
    s_add_u32 s56, s56, 262144
    v_lshrrev_b32 v6, 5, v1
    v_lshl_add_u32 v6, v6, 2, v3
    s_lshl_b32 s60, s10, 5
    v_add_u32 v6, s60, v6
    v_mul_u32_u24 v6, 1152, v6
    v_and_b32 v7, 1, v4
    v_lshlrev_b32 v7, 6, v7
    v_lshl_add_u32 v7, v2, 4, v7
    v_add_u32 v20, v6, v7
    v_add_u32 v21, 8192, v20
    v_add_u32 v22, 16384, v20
    v_add_u32 v23, 24576, v20
    s_mul_i32 s67, s7, 294912
    v_lshlrev_b32 v26, 4, v1
    v_add_u32 v26, s3, v26
    v_add_u32 v27, 98304, v26
    s_mov_b32 s48, s94
    s_mov_b32 s49, s95
    s_mov_b32 s50, 1179648
    s_mov_b32 s51, 0x20000
    s_mov_b32 s52, s96
    s_mov_b32 s53, s97
    s_mov_b32 s54, 256
    s_mov_b32 s55, 0x20000
    s_mov_b32 s44, s98
    s_mov_b32 s45, s99
    s_mov_b32 s46, 18911232
    s_mov_b32 s47, 0x20000
    s_waitcnt vmcnt(8)
    s_barrier
    s_add_u32 m0, s22, 32768
    s_nop 0
    buffer_load_dwordx4 v14, s[24:27], s57 offen offset:0  lds
    buffer_load_dwordx4 v15, s[24:27], s57 offen offset:1024  lds
    s_add_u32 s57, s57, 128
    s_cmp_eq_u32 s57, s62
    s_cselect_b32 s60, 1152, 0
    s_sub_u32 s57, s57, s60
    s_add_u32 m0, s3, 16384
    s_nop 0
    buffer_load_dwordx4 v10, s[28:31], s56 offen offset:0  lds
    buffer_load_dwordx4 v11, s[28:31], s56 offen offset:1024  lds
    buffer_load_dwordx4 v12, s[28:31], s56 offen offset:2048  lds
    buffer_load_dwordx4 v13, s[28:31], s56 offen offset:3072  lds
    s_add_u32 s56, s56, 262144
    s_cmp_eq_u32 s56, s58
    s_cselect_b32 s60, 4718592, 0
    s_sub_u32 s56, s56, s60
    s_waitcnt vmcnt(10)
    s_barrier
    s_add_u32 m0, s3, 49152
    s_nop 0
    buffer_load_dwordx4 v10, s[28:31], s56 offen offset:0  lds
    buffer_load_dwordx4 v11, s[28:31], s56 offen offset:1024  lds
    buffer_load_dwordx4 v12, s[28:31], s56 offen offset:2048  lds
    buffer_load_dwordx4 v13, s[28:31], s56 offen offset:3072  lds
    s_add_u32 s56, s56, 262144
    s_waitcnt vmcnt(8)
    s_barrier
    s_add_u32 m0, s22, 40960
    s_nop 0
    buffer_load_dwordx4 v14, s[24:27], s57 offen offset:0  lds
    buffer_load_dwordx4 v15, s[24:27], s57 offen offset:1024  lds
    s_add_u32 s57, s57, 128
    s_cmp_eq_u32 s57, s62
    s_cselect_b32 s60, 1152, 0
    s_sub_u32 s57, s57, s60
    s_add_u32 m0, s3, 65536
    s_nop 0
    buffer_load_dwordx4 v10, s[28:31], s56 offen offset:0  lds
    buffer_load_dwordx4 v11, s[28:31], s56 offen offset:1024  lds
    buffer_load_dwordx4 v12, s[28:31], s56 offen offset:2048  lds
    buffer_load_dwordx4 v13, s[28:31], s56 offen offset:3072  lds
    s_add_u32 s56, s56, 262144
    s_cmp_eq_u32 s56, s58
    s_cselect_b32 s60, 4718592, 0
    s_sub_u32 s56, s56, s60
    s_waitcnt vmcnt(10)
    s_barrier
    s_add_u32 m0, s3, 0
    s_nop 0
    buffer_load_dwordx4 v10, s[28:31], s56 offen offset:0  lds
    buffer_load_dwordx4 v11, s[28:31], s56 offen offset:1024  lds
    buffer_load_dwordx4 v12, s[28:31], s56 offen offset:2048  lds
    buffer_load_dwordx4 v13, s[28:31], s56 offen offset:3072  lds
    s_add_u32 s56, s56, 262144
    s_waitcnt vmcnt(8)
    s_barrier
    s_add_u32 m0, s22, 32768
    s_nop 0
    buffer_load_dwordx4 v14, s[24:27], s57 offen offset:0  lds
    buffer_load_dwordx4 v15, s[24:27], s57 offen offset:1024  lds
    s_add_u32 s57, s57, 128
    s_cmp_eq_u32 s57, s62
    s_cselect_b32 s60, 1152, 0
    s_sub_u32 s57, s57, s60
    s_add_u32 m0, s3, 16384
    s_nop 0
    buffer_load_dwordx4 v10, s[28:31], s56 offen offset:0  lds
    buffer_load_dwordx4 v11, s[28:31], s56 offen offset:1024  lds
    buffer_load_dwordx4 v12, s[28:31], s56 offen offset:2048  lds
    buffer_load_dwordx4 v13, s[28:31], s56 offen offset:3072  lds
    s_add_u32 s56, s56, 262144
    s_cmp_eq_u32 s56, s58
    s_cselect_b32 s60, 4718592, 0
    s_sub_u32 s56, s56, s60
    s_waitcnt vmcnt(10)
    s_barrier
    s_add_u32 m0, s3, 49152
    s_nop 0
    buffer_load_dwordx4 v10, s[28:31], s56 offen offset:0  lds
    buffer_load_dwordx4 v11, s[28:31], s56 offen offset:1024  lds
    buffer_load_dwordx4 v12, s[28:31], s56 offen offset:2048  lds
    buffer_load_dwordx4 v13, s[28:31], s56 offen offset:3072  lds
    s_add_u32 s56, s56, 262144
    s_waitcnt vmcnt(8)
    s_barrier
    s_add_u32 m0, s22, 40960
    s_nop 0
    buffer_load_dwordx4 v14, s[24:27], s57 offen offset:0  lds
    buffer_load_dwordx4 v15, s[24:27], s57 offen offset:1024  lds
    s_add_u32 s57, s57, 128
    s_cmp_eq_u32 s57, s62
    s_cselect_b32 s60, 1152, 0
    s_sub_u32 s57, s57, s60
    s_add_u32 m0, s3, 65536
    s_nop 0
    buffer_load_dwordx4 v10, s[28:31], s56 offen offset:0  lds
    buffer_load_dwordx4 v11, s[28:31], s56 offen offset:1024  lds
    buffer_load_dwordx4 v12, s[28:31], s56 offen offset:2048  lds
    buffer_load_dwordx4 v13, s[28:31], s56 offen offset:3072  lds
    s_add_u32 s56, s56, 262144
    s_cmp_eq_u32 s56, s58
    s_cselect_b32 s60, 4718592, 0
    s_sub_u32 s56, s56, s60
    s_waitcnt vmcnt(10)
    s_barrier
    s_add_u32 m0, s3, 0
    s_nop 0
    buffer_load_dwordx4 v10, s[28:31], s56 offen offset:0  lds
    buffer_load_dwordx4 v11, s[28:31], s56 offen offset:1024  lds
    buffer_load_dwordx4 v12, s[28:31], s56 offen offset:2048  lds
    buffer_load_dwordx4 v13, s[28:31], s56 offen offset:3072  lds
    s_add_u32 s56, s56, 262144
    s_waitcnt vmcnt(8)
    s_barrier
    s_add_u32 m0, s22, 32768
    s_nop 0
    buffer_load_dwordx4 v14, s[24:27], s57 offen offset:0  lds
    buffer_load_dwordx4 v15, s[24:27], s57 offen offset:1024  lds
    s_add_u32 s57, s57, 128
    s_cmp_eq_u32 s57, s62
    s_cselect_b32 s60, 1152, 0
    s_sub_u32 s57, s57, s60
    s_add_u32 m0, s3, 16384
    s_nop 0
    buffer_load_dwordx4 v10, s[28:31], s56 offen offset:0  lds
    buffer_load_dwordx4 v11, s[28:31], s56 offen offset:1024  lds
    buffer_load_dwordx4 v12, s[28:31], s56 offen offset:2048  lds
    buffer_load_dwordx4 v13, s[28:31], s56 offen offset:3072  lds
    s_add_u32 s56, s56, 262144
    s_cmp_eq_u32 s56, s58
    s_cselect_b32 s60, 4718592, 0
    s_sub_u32 s56, s56, s60
    s_waitcnt vmcnt(10)
    s_barrier
    s_add_u32 m0, s3, 49152
    s_nop 0
    buffer_load_dwordx4 v10, s[28:31], s56 offen offset:0  lds
    buffer_load_dwordx4 v11, s[28:31], s56 offen offset:1024  lds
    buffer_load_dwordx4 v12, s[28:31], s56 offen offset:2048  lds
    buffer_load_dwordx4 v13, s[28:31], s56 offen offset:3072  lds
    s_add_u32 s56, s56, 262144
    s_waitcnt vmcnt(8)
    s_barrier
    s_add_u32 m0, s22, 40960
    s_nop 0
    buffer_load_dwordx4 v14, s[24:27], s57 offen offset:0  lds
    buffer_load_dwordx4 v15, s[24:27], s57 offen offset:1024  lds
    s_add_u32 s57, s57, 128
    s_cmp_eq_u32 s57, s62
    s_cselect_b32 s60, 1152, 0
    s_sub_u32 s57, s57, s60
    s_add_u32 m0, s3, 65536
    s_nop 0
    buffer_load_dwordx4 v10, s[28:31], s56 offen offset:0  lds
    buffer_load_dwordx4 v11, s[28:31], s56 offen offset:1024  lds
    buffer_load_dwordx4 v12, s[28:31], s56 offen offset:2048  lds
    buffer_load_dwordx4 v13, s[28:31], s56 offen offset:3072  lds
    s_add_u32 s56, s56, 262144
    s_cmp_eq_u32 s56, s58
    s_cselect_b32 s60, 4718592, 0
    s_sub_u32 s56, s56, s60
    s_waitcnt vmcnt(10)
    s_barrier
    s_add_u32 m0, s3, 0
    s_nop 0
    buffer_load_dwordx4 v10, s[28:31], s56 offen offset:0  lds
    buffer_load_dwordx4 v11, s[28:31], s56 offen offset:1024  lds
    buffer_load_dwordx4 v12, s[28:31], s56 offen offset:2048  lds
    buffer_load_dwordx4 v13, s[28:31], s56 offen offset:3072  lds
    s_add_u32 s56, s56, 262144
    s_add_u32 m0, s3, 131072
    s_xor_b32 s60, s59, 0
    buffer_load_dwordx4 v16, s[32:35], s60 offen offset:0 nt lds
    buffer_load_dwordx4 v17, s[32:35], s60 offen offset:1024 nt lds
    buffer_load_dwordx4 v18, s[32:35], s60 offen offset:2048 nt lds
    buffer_load_dwordx4 v19, s[32:35], s60 offen offset:3072 nt lds
    s_add_u32 m0, s3, 147456
    s_xor_b32 s60, s59, 16384
    buffer_load_dwordx4 v16, s[32:35], s60 offen offset:0 nt lds
    buffer_load_dwordx4 v17, s[32:35], s60 offen offset:1024 nt lds
    buffer_load_dwordx4 v18, s[32:35], s60 offen offset:2048 nt lds
    buffer_load_dwordx4 v19, s[32:35], s60 offen offset:3072 nt lds
    s_add_u32 m0, s3, 81920
    s_xor_b32 s60, s59, 0
    buffer_load_dwordx4 v16, s[36:39], s60 offen offset:0 nt lds
    buffer_load_dwordx4 v16, s[36:39], s60 offen offset:1024 nt lds
    buffer_load_dwordx4 v16, s[36:39], s60 offen offset:2048 nt lds
    buffer_load_dwordx4 v16, s[36:39], s60 offen offset:3072 nt lds
    s_add_u32 m0, s3, 98304
    s_xor_b32 s60, s59, 32768
    buffer_load_dwordx4 v16, s[32:35], s60 offen offset:0 nt lds
    buffer_load_dwordx4 v17, s[32:35], s60 offen offset:1024 nt lds
    buffer_load_dwordx4 v18, s[32:35], s60 offen offset:2048 nt lds
    buffer_load_dwordx4 v19, s[32:35], s60 offen offset:3072 nt lds
    s_add_u32 m0, s3, 114688
    s_xor_b32 s60, s59, 49152
    buffer_load_dwordx4 v16, s[32:35], s60 offen offset:0 nt lds
    buffer_load_dwordx4 v17, s[32:35], s60 offen offset:1024 nt lds
    buffer_load_dwordx4 v18, s[32:35], s60 offen offset:2048 nt lds
    buffer_load_dwordx4 v19, s[32:35], s60 offen offset:3072 nt lds
    s_waitcnt vmcnt(28)
    s_barrier
    s_add_u32 m0, s22, 32768
    s_nop 0
    buffer_load_dwordx4 v14, s[24:27], s57 offen offset:0  lds
    buffer_load_dwordx4 v15, s[24:27], s57 offen offset:1024  lds
    s_add_u32 m0, s3, 16384
    s_nop 0
    buffer_load_dwordx4 v10, s[28:31], s56 offen offset:0  lds
    buffer_load_dwordx4 v11, s[28:31], s56 offen offset:1024  lds
    buffer_load_dwordx4 v12, s[28:31], s56 offen offset:2048  lds
    buffer_load_dwordx4 v13, s[28:31], s56 offen offset:3072  lds
    s_add_u32 s56, s56, 262144
    s_waitcnt vmcnt(30)
    s_barrier
    s_waitcnt vmcnt(4)
    s_barrier
    v_mov_b32 v31, 40960
    s_cmp_lg_u32 s9, 4
    s_cbranch_scc1 L_nv3
    s_waitcnt lgkmcnt(0)
    s_lshr_b32 s60, s70, s2
    s_and_b32 s60, s60, 1
    v_mov_b32 v30, s60
    ds_write_b32 v31, v30
L_nv3:
    s_add_u32 m0, s3, 65536
    s_xor_b32 s60, s59, 16384
    buffer_load_dwordx4 v16, s[36:39], s60 offen offset:0 nt lds
    buffer_load_dwordx4 v16, s[36:39], s60 offen offset:1024 nt lds
    buffer_load_dwordx4 v16, s[36:39], s60 offen offset:2048 nt lds
    buffer_load_dwordx4 v16, s[36:39], s60 offen offset:3072 nt lds
    s_add_u32 m0, s3, 49152
    s_xor_b32 s60, s59, 32768
    buffer_load_dwordx4 v16, s[36:39], s60 offen offset:0 nt lds
    buffer_load_dwordx4 v16, s[36:39], s60 offen offset:1024 nt lds
    buffer_load_dwordx4 v16, s[36:39], s60 offen offset:2048 nt lds
    buffer_load_dwordx4 v16, s[36:39], s60 offen offset:3072 nt lds
    s_waitcnt lgkmcnt(0)
    s_waitcnt vmcnt(8)
    s_barrier
L_ltail:
    ds_read_b32 v30, v31
    s_lshl3_add_u32 s63, s6, s8
    s_mul_i32 s63, s63, 2304
    s_add_u32 s63, s63, 18874368
    s_and_b32 s60, s7, 7
    s_lshl4_add_u32 s63, s60, s63
    s_lshr_b32 s60, s7, 3
    s_lshl3_add_u32 s63, s60, s63
    s_lshr_b32 s60, s10, 1
    s_lshl2_add_u32 s63, s60, s63
    s_and_b32 s60, s10, 1
    s_lshl_b32 s60, s60, 10
    s_add_u32 s63, s63, s60
    v_and_b32 v24, 63, v0
    v_lshrrev_b32 v25, 2, v24
    v_lshlrev_b32 v25, 25, v25
    v_bfe_u32 v29, v24, 3, 2
    v_lshl_add_u32 v25, v29, 11, v25
    v_and_b32 v24, 7, v24
    v_lshl_add_u32 v25, v24, 8, v25
    v_add_u32 v28, s63, v25
    v_mov_b32 v29, 0
    s_waitcnt lgkmcnt(0)
    v_readfirstlane_b32 s60, v30
    s_cmp_lg_u32 s60, 0
    s_cbranch_scc1 L_conf
    s_barrier
    buffer_store_dword v29, v28, s[44:47], 0 offen offset:0 sc1
    s_add_u32 m0, s3, 32768
    s_xor_b32 s60, s59, 49152
    buffer_load_dwordx4 v16, s[36:39], s60 offen offset:0 nt lds
    buffer_load_dwordx4 v16, s[36:39], s60 offen offset:1024 nt lds
    buffer_load_dwordx4 v16, s[36:39], s60 offen offset:2048 nt lds
    buffer_load_dwordx4 v16, s[36:39], s60 offen offset:3072 nt lds
    s_barrier
    s_add_u32 m0, s3, 16384
    s_xor_b32 s60, s59, 65536
    buffer_load_dwordx4 v16, s[32:35], s60 offen offset:0 nt lds
    buffer_load_dwordx4 v17, s[32:35], s60 offen offset:1024 nt lds
    buffer_load_dwordx4 v18, s[32:35], s60 offen offset:2048 nt lds
    buffer_load_dwordx4 v19, s[32:35], s60 offen offset:3072 nt lds
    s_waitcnt vmcnt(13)
    s_barrier
    s_add_u32 m0, s3, 0
    s_xor_b32 s60, s59, 65536
    buffer_load_dwordx4 v16, s[36:39], s60 offen offset:0 nt lds
    buffer_load_dwordx4 v16, s[36:39], s60 offen offset:1024 nt lds
    buffer_load_dwordx4 v16, s[36:39], s60 offen offset:2048 nt lds
    buffer_load_dwordx4 v16, s[36:39], s60 offen offset:3072 nt lds
    s_waitcnt vmcnt(13)
    s_barrier
    s_add_u32 m0, s3, 131072
    s_xor_b32 s60, s59, 81920
    buffer_load_dwordx4 v16, s[32:35], s60 offen offset:0 nt lds
    buffer_load_dwordx4 v17, s[32:35], s60 offen offset:1024 nt lds
    buffer_load_dwordx4 v18, s[32:35], s60 offen offset:2048 nt lds
    buffer_load_dwordx4 v19, s[32:35], s60 offen offset:3072 nt lds
    s_add_u32 m0, s3, 81920
    s_xor_b32 s60, s59, 81920
    buffer_load_dwordx4 v16, s[36:39], s60 offen offset:0 nt lds
    buffer_load_dwordx4 v16, s[36:39], s60 offen offset:1024 nt lds
    buffer_load_dwordx4 v16, s[36:39], s60 offen offset:2048 nt lds
    buffer_load_dwordx4 v16, s[36:39], s60 offen offset:3072 nt lds
    s_waitcnt vmcnt(12)
    s_barrier
    s_add_u32 m0, s3, 147456
    s_xor_b32 s60, s59, 98304
    buffer_load_dwordx4 v16, s[32:35], s60 offen offset:0 nt lds
    buffer_load_dwordx4 v17, s[32:35], s60 offen offset:1024 nt lds
    buffer_load_dwordx4 v18, s[32:35], s60 offen offset:2048 nt lds
    buffer_load_dwordx4 v19, s[32:35], s60 offen offset:3072 nt lds
    s_waitcnt vmcnt(8)
    s_barrier
    s_add_u32 m0, s3, 65536
    s_xor_b32 s60, s59, 98304
    buffer_load_dwordx4 v16, s[36:39], s60 offen offset:0 nt lds
    buffer_load_dwordx4 v16, s[36:39], s60 offen offset:1024 nt lds
    buffer_load_dwordx4 v16, s[36:39], s60 offen offset:2048 nt lds
    buffer_load_dwordx4 v16, s[36:39], s60 offen offset:3072 nt lds
    s_add_u32 m0, s3, 98304
    s_xor_b32 s60, s59, 114688
    buffer_load_dwordx4 v16, s[32:35], s60 offen offset:0 nt lds
    buffer_load_dwordx4 v17, s[32:35], s60 offen offset:1024 nt lds
    buffer_load_dwordx4 v18, s[32:35], s60 offen offset:2048 nt lds
    buffer_load_dwordx4 v19, s[32:35], s60 offen offset:3072 nt lds
    v_and_b32 v1, 63, v0
    v_and_b32 v2, 7, v1
    v_lshlrev_b32 v4, 4, v2
    v_bfe_u32 v3, v1, 3, 1
    v_lshl_add_u32 v4, v3, 14, v4
    v_lshlrev_b32 v5, 5, v3
    v_bfe_u32 v6, v1, 1, 3
    v_bfe_u32 v3, v1, 4, 1
    v_lshl_add_u32 v4, v3, 16, v4
    v_lshl_add_u32 v5, v3, 3, v5
    v_lshlrev_b32 v3, 2, v3
    v_xor_b32 v6, v6, v3
    v_lshrrev_b32 v3, 5, v1
    v_lshl_add_u32 v4, v3, 13, v4
    v_lshl_add_u32 v5, v3, 6, v5
    v_bfe_u32 v3, v1, 2, 1
    v_lshl_add_u32 v5, v3, 4, v5
    v_and_b32 v3, 3, v1
    v_mul_u32_u24 v3, 2304, v3
    v_add_u32 v5, v5, v3
    v_and_b32 v3, 1, v1
    v_lshlrev_b32 v3, 4, v3
    v_mov_b32 v7, 0x3f80
    v_lshlrev_b32 v3, v3, v7
    v_cmp_eq_u32 s[12:13], 0, v6
    v_cmp_eq_u32 s[14:15], 1, v6
    v_cmp_eq_u32 s[16:17], 2, v6
    v_cmp_eq_u32 s[18:19], 3, v6
    v_cndmask_b32 v8, 0, v3, s[12:13]
    v_cndmask_b32 v9, 0, v3, s[14:15]
    v_cndmask_b32 v10, 0, v3, s[16:17]
    v_cndmask_b32 v11, 0, v3, s[18:19]
    v_and_b32 v1, 31, v1
    v_lshlrev_b32 v1, 2, v1
    s_lshl3_add_u32 s56, s6, s8
    s_mul_i32 s68, s56, 1179648
    s_mul_i32 s22, s56, 2304
    s_add_u32 s22, s22, 18874368
    s_lshl_b32 s56, s56, 4
    s_lshr_b32 s60, s7, 1
    s_lshl_b32 s60, s60, 8
    s_add_u32 s22, s22, s60
    s_mul_i32 s69, s8, 147456
    s_mul_i32 s60, s6, 1152
    s_add_u32 s69, s69, s60
    s_waitcnt vmcnt(8)
    s_barrier
    s_add_u32 m0, s3, 49152
    s_xor_b32 s60, s59, 114688
    buffer_load_dwordx4 v16, s[36:39], s60 offen offset:0 nt lds
    buffer_load_dwordx4 v16, s[36:39], s60 offen offset:1024 nt lds
    buffer_load_dwordx4 v16, s[36:39], s60 offen offset:2048 nt lds
    buffer_load_dwordx4 v16, s[36:39], s60 offen offset:3072 nt lds
    s_add_u32 s61, s8, 0
    s_cmp_ge_u32 s61, 9
    s_cselect_b32 s60, 9, 0
    s_sub_u32 s61, s61, s60
    s_lshl_b32 s61, s61, 7
    s_add_u32 s61, s61, s67
    s_add_u32 m0, s3, 0
    s_nop 0
    buffer_load_dwordx4 v20, s[40:43], s61 offen offset:0  lds
    buffer_load_dwordx4 v21, s[40:43], s61 offen offset:1024  lds
    buffer_load_dwordx4 v22, s[40:43], s61 offen offset:2048  lds
    buffer_load_dwordx4 v23, s[40:43], s61 offen offset:3072  lds
    s_waitcnt vmcnt(8)
    s_barrier
    s_cmp_lg_u32 s9, 4
    s_cbranch_scc1 L_nordy
    s_lshl3_add_u32 s63, s6, s8
    s_lshl_b32 s63, s63, 4
    s_add_u32 s63, s63, 4
    s_lshl_b32 s70, 1, s7
    s_atomic_or s70, s[96:97], s63
L_nordy:
    s_add_u32 s61, s8, 0
    s_cmp_ge_u32 s61, 9
    s_cselect_b32 s60, 9, 0
    s_sub_u32 s61, s61, s60
    s_lshl_b32 s61, s61, 7
    s_add_u32 s61, s61, s67
    s_add_u32 m0, s3, 16384
    s_add_u32 s61, s61, 147456
    buffer_load_dwordx4 v20, s[40:43], s61 offen offset:0  lds
    buffer_load_dwordx4 v21, s[40:43], s61 offen offset:1024  lds
    buffer_load_dwordx4 v22, s[40:43], s61 offen offset:2048  lds
    buffer_load_dwordx4 v23, s[40:43], s61 offen offset:3072  lds
    s_add_u32 s61, s8, 1
    s_cmp_ge_u32 s61, 9
    s_cselect_b32 s60, 9, 0
    s_sub_u32 s61, s61, s60
    s_lshl_b32 s61, s61, 7
    s_add_u32 s61, s61, s67
    s_add_u32 m0, s3, 131072
    s_nop 0
    buffer_load_dwordx4 v20, s[40:43], s61 offen offset:0  lds
    buffer_load_dwordx4 v21, s[40:43], s61 offen offset:1024  lds
    buffer_load_dwordx4 v22, s[40:43], s61 offen offset:2048  lds
    buffer_load_dwordx4 v23, s[40:43], s61 offen offset:3072  lds
    s_waitcnt vmcnt(12)
    s_barrier
    s_add_u32 s61, s8, 1
    s_cmp_ge_u32 s61, 9
    s_cselect_b32 s60, 9, 0
    s_sub_u32 s61, s61, s60
    s_lshl_b32 s61, s61, 7
    s_add_u32 s61, s61, s67
    s_add_u32 m0, s3, 147456
    s_add_u32 s61, s61, 147456
    buffer_load_dwordx4 v20, s[40:43], s61 offen offset:0  lds
    buffer_load_dwordx4 v21, s[40:43], s61 offen offset:1024  lds
    buffer_load_dwordx4 v22, s[40:43], s61 offen offset:2048  lds
    buffer_load_dwordx4 v23, s[40:43], s61 offen offset:3072  lds
    s_waitcnt vmcnt(8)
    s_barrier
    s_add_u32 s61, s8, 2
    s_cmp_ge_u32 s61, 9
    s_cselect_b32 s60, 9, 0
    s_sub_u32 s61, s61, s60
    s_lshl_b32 s61, s61, 7
    s_add_u32 s61, s61, s67
    s_add_u32 m0, s3, 98304
    s_nop 0
    buffer_load_dwordx4 v20, s[40:43], s61 offen offset:0  lds
    buffer_load_dwordx4 v21, s[40:43], s61 offen offset:1024  lds
    buffer_load_dwordx4 v22, s[40:43], s61 offen offset:2048  lds
    buffer_load_dwordx4 v23, s[40:43], s61 offen offset:3072  lds
    s_add_u32 m0, s3, 114688
    s_add_u32 s61, s61, 147456
    buffer_load_dwordx4 v20, s[40:43], s61 offen offset:0  lds
    buffer_load_dwordx4 v21, s[40:43], s61 offen offset:1024  lds
    buffer_load_dwordx4 v22, s[40:43], s61 offen offset:2048  lds
    buffer_load_dwordx4 v23, s[40:43], s61 offen offset:3072  lds
    s_add_u32 s61, s8, 8
    s_cmp_ge_u32 s61, 9
    s_cselect_b32 s60, 9, 0
    s_sub_u32 s61, s61, s60
    s_lshl_b32 s61, s61, 7
    s_add_u32 s61, s61, s67
    buffer_load_dwordx4 v[192:195], v20, s[40:43], s61 offen offset:0
    buffer_load_dwordx4 v[196:199], v21, s[40:43], s61 offen offset:1024
    buffer_load_dwordx4 v[200:203], v22, s[40:43], s61 offen offset:2048
    buffer_load_dwordx4 v[204:207], v23, s[40:43], s61 offen offset:3072
    s_add_u32 s61, s61, 147456
    buffer_load_dwordx4 v[208:211], v20, s[40:43], s61 offen offset:0
    buffer_load_dwordx4 v[212:215], v21, s[40:43], s61 offen offset:1024
    buffer_load_dwordx4 v[216:219], v22, s[40:43], s61 offen offset:2048
    buffer_load_dwordx4 v[220:223], v23, s[40:43], s61 offen offset:3072
    s_waitcnt vmcnt(16)
    s_barrier
    s_add_u32 s61, s8, 3
    s_cmp_ge_u32 s61, 9
    s_cselect_b32 s60, 9, 0
    s_sub_u32 s61, s61, s60
    s_lshl_b32 s61, s61, 7
    s_add_u32 s61, s61, s67
    s_add_u32 m0, s3, 32768
    s_nop 0
    buffer_load_dwordx4 v20, s[40:43], s61 offen offset:0  lds
    buffer_load_dwordx4 v21, s[40:43], s61 offen offset:1024  lds
    buffer_load_dwordx4 v22, s[40:43], s61 offen offset:2048  lds
    buffer_load_dwordx4 v23, s[40:43], s61 offen offset:3072  lds
    s_add_u32 m0, s3, 49152
    s_add_u32 s61, s61, 147456
    buffer_load_dwordx4 v20, s[40:43], s61 offen offset:0  lds
    buffer_load_dwordx4 v21, s[40:43], s61 offen offset:1024  lds
    buffer_load_dwordx4 v22, s[40:43], s61 offen offset:2048  lds
    buffer_load_dwordx4 v23, s[40:43], s61 offen offset:3072  lds
    s_add_u32 s61, s8, 4
    s_cmp_ge_u32 s61, 9
    s_cselect_b32 s60, 9, 0
    s_sub_u32 s61, s61, s60
    s_lshl_b32 s61, s61, 7
    s_add_u32 s61, s61, s67
    s_add_u32 m0, s3, 0
    s_nop 0
    buffer_load_dwordx4 v20, s[40:43], s61 offen offset:0  lds
    buffer_load_dwordx4 v21, s[40:43], s61 offen offset:1024  lds
    buffer_load_dwordx4 v22, s[40:43], s61 offen offset:2048  lds
    buffer_load_dwordx4 v23, s[40:43], s61 offen offset:3072  lds
    s_add_u32 m0, s3, 16384
    s_add_u32 s61, s61, 147456
    buffer_load_dwordx4 v20, s[40:43], s61 offen offset:0  lds
    buffer_load_dwordx4 v21, s[40:43], s61 offen offset:1024  lds
    buffer_load_dwordx4 v22, s[40:43], s61 offen offset:2048  lds
    buffer_load_dwordx4 v23, s[40:43], s61 offen offset:3072  lds
    s_waitcnt vmcnt(24)
    s_barrier
    s_add_u32 s61, s8, 5
    s_cmp_ge_u32 s61, 9
    s_cselect_b32 s60, 9, 0
    s_sub_u32 s61, s61, s60
    s_lshl_b32 s61, s61, 7
    s_add_u32 s61, s61, s67
    s_add_u32 m0, s3, 65536
    s_nop 0
    buffer_load_dwordx4 v20, s[40:43], s61 offen offset:0  lds
    buffer_load_dwordx4 v21, s[40:43], s61 offen offset:1024  lds
    buffer_load_dwordx4 v22, s[40:43], s61 offen offset:2048  lds
    buffer_load_dwordx4 v23, s[40:43], s61 offen offset:3072  lds
    s_waitcnt vmcnt(12)
    s_barrier
    s_add_u32 s61, s8, 5
    s_cmp_ge_u32 s61, 9
    s_cselect_b32 s60, 9, 0
    s_sub_u32 s61, s61, s60
    s_lshl_b32 s61, s61, 7
    s_add_u32 s61, s61, s67
    s_add_u32 m0, s3, 81920
    s_add_u32 s61, s61, 147456
    buffer_load_dwordx4 v20, s[40:43], s61 offen offset:0  lds
    buffer_load_dwordx4 v21, s[40:43], s61 offen offset:1024  lds
    buffer_load_dwordx4 v22, s[40:43], s61 offen offset:2048  lds
    buffer_load_dwordx4 v23, s[40:43], s61 offen offset:3072  lds
    s_add_u32 s61, s8, 6
    s_cmp_ge_u32 s61, 9
    s_cselect_b32 s60, 9, 0
    s_sub_u32 s61, s61, s60
    s_lshl_b32 s61, s61, 7
    s_add_u32 s61, s61, s67
    s_add_u32 m0, s3, 131072
    s_nop 0
    buffer_load_dwordx4 v20, s[40:43], s61 offen offset:0  lds
    buffer_load_dwordx4 v21, s[40:43], s61 offen offset:1024  lds
    buffer_load_dwordx4 v22, s[40:43], s61 offen offset:2048  lds
    buffer_load_dwordx4 v23, s[40:43], s61 offen offset:3072  lds
    s_waitcnt vmcnt(12)
    s_barrier
    s_cmp_lg_u32 s10, 0
    s_cbranch_scc1 L_nord
    buffer_load_dword v3, off, s[52:55], s56 offset:4 sc1
L_nord:
    s_add_u32 s61, s8, 6
    s_cmp_ge_u32 s61, 9
    s_cselect_b32 s60, 9, 0
    s_sub_u32 s61, s61, s60
    s_lshl_b32 s61, s61, 7
    s_add_u32 s61, s61, s67
    s_add_u32 m0, s3, 147456
    s_add_u32 s61, s61, 147456
    buffer_load_dwordx4 v20, s[40:43], s61 offen offset:0  lds
    buffer_load_dwordx4 v21, s[40:43], s61 offen offset:1024  lds
    buffer_load_dwordx4 v22, s[40:43], s61 offen offset:2048  lds
    buffer_load_dwordx4 v23, s[40:43], s61 offen offset:3072  lds
    s_add_u32 s61, s8, 7
    s_cmp_ge_u32 s61, 9
    s_cselect_b32 s60, 9, 0
    s_sub_u32 s61, s61, s60
    s_lshl_b32 s61, s61, 7
    s_add_u32 s61, s61, s67
    s_add_u32 m0, s3, 98304
    s_nop 0
    buffer_load_dwordx4 v20, s[40:43], s61 offen offset:0  lds
    buffer_load_dwordx4 v21, s[40:43], s61 offen offset:1024  lds
    buffer_load_dwordx4 v22, s[40:43], s61 offen offset:2048  lds
    buffer_load_dwordx4 v23, s[40:43], s61 offen offset:3072  lds
    s_waitcnt vmcnt(12)
    s_barrier
    ds_write_b128 v26, v[192:195] offset:32768
    ds_write_b128 v26, v[196:199] offset:33792
    ds_write_b128 v26, v[200:203] offset:34816
    ds_write_b128 v26, v[204:207] offset:35840
    s_add_u32 s61, s8, 7
    s_cmp_ge_u32 s61, 9
    s_cselect_b32 s60, 9, 0
    s_sub_u32 s61, s61, s60
    s_lshl_b32 s61, s61, 7
    s_add_u32 s61, s61, s67
    s_add_u32 m0, s3, 114688
    s_add_u32 s61, s61, 147456
    buffer_load_dwordx4 v20, s[40:43], s61 offen offset:0  lds
    buffer_load_dwordx4 v21, s[40:43], s61 offen offset:1024  lds
    buffer_load_dwordx4 v22, s[40:43], s61 offen offset:2048  lds
    buffer_load_dwordx4 v23, s[40:43], s61 offen offset:3072  lds
    s_waitcnt vmcnt(8)
    s_barrier
    v_mov_b32 v2, 0
    v_mov_b32 v6, 0
    v_and_b32 v7, 63, v0
    v_lshl_add_u32 v7, v7, 2, v6
    ds_write_b32 v7, v2
    ds_write_b128 v26, v[208:211] offset:49152
    ds_write_b128 v26, v[212:215] offset:50176
    ds_write_b128 v26, v[216:219] offset:51200
    ds_write_b128 v26, v[220:223] offset:52224
    s_waitcnt lgkmcnt(0)
    s_waitcnt vmcnt(0)
    s_barrier
    s_mov_b32 s57, s7
    s_mov_b32 s58, 0
    s_mov_b32 s71, 9
    s_mov_b32 s11, 1
    s_cmp_lg_u32 s10, 0
    s_cbranch_scc1 L_pair
    s_and_b32 s60, s7, 7
    s_lshr_b32 s61, s7, 3
    s_lshl1_add_u32 s60, s60, s61
    v_lshrrev_b32 v31, 3, v1
    v_cmp_eq_u32 vcc, s60, v31
    s_nop 1
    v_cndmask_b32 v31, 0, -1, vcc
    s_mov_b32 s71, 0x10000
    v_add_u32 v30, 4096, v1
    s_mov_b32 s62, 0
    s_mov_b32 s66, 0
    v_mov_b32 v16, 0
    s_waitcnt vmcnt(0)
    v_readfirstlane_b32 s70, v3
L_rdy:
    s_cmp_eq_u32 s70, 0xffff
    s_cbranch_scc1 L_poll
    buffer_load_dword v3, off, s[52:55], s56 offset:4 sc1
    s_add_u32 s62, s62, 1
    s_waitcnt vmcnt(0)
    v_readfirstlane_b32 s70, v3
    s_cmp_lt_u32 s62, 4000
    s_cbranch_scc1 L_rdy
    s_branch L_aband
L_poll:
    buffer_load_dword v16, v1, s[44:47], s22 offen offset:0 sc1
    s_waitcnt vmcnt(0)
    v_or_b32 v16, v16, v31
    v_cmp_eq_u32 vcc, 0, v16
    s_quadmask_b32 s60, vcc_lo
    s_andn2_b32 s60, 255, s60
    s_or_b32 s66, s66, s60
    v_mov_b32 v3, s66
    ds_write_b32 v6, v3 offset:8
    s_cmp_eq_u32 s66, 255
    s_cbranch_scc1 L_pend
    s_add_u32 s62, s62, 1
    s_cmp_lt_u32 s62, 4000
    s_cbranch_scc1 L_poll
L_aband:
    s_lshl_b32 s60, 65536, s57
    s_atomic_or s60, s[96:97], s56 glc
    s_waitcnt vmcnt(0) lgkmcnt(0)
    s_mov_b32 s61, 256
    s_and_b32 s60, s60, 0xff
    s_cmp_eq_u32 s60, 16
    s_cselect_b32 s66, 255, s61
    v_mov_b32 v3, s66
    ds_write_b32 v6, v3 offset:8
L_pend:
    s_waitcnt vmcnt(0) lgkmcnt(0)
    s_branch L_fin
L_chunk:
    s_add_u32 s61, s8, s70
    s_cmp_ge_u32 s61, 9
    s_cselect_b32 s60, 9, 0
    s_sub_u32 s61, s61, s60
    s_lshl_b32 s65, s61, 7
    s_add_u32 s65, s65, s69
    s_mul_i32 s60, s57, 9216
    s_add_u32 s65, s65, s60
    s_lshl_b32 s59, s61, 17
    s_add_u32 s59, s59, s68
    s_lshr_b32 s60, s57, 3
    s_lshl_b32 s60, s60, 15
    s_and_b32 s61, s57, 7
    s_lshl_b32 s61, s61, 7
    s_add_u32 s59, s59, s60
    s_add_u32 s59, s59, s61
    s_add_u32 s64, s59, 4096
    s_cmp_eq_u32 s11, 0
    s_cbranch_scc1 L_go
L_wait:
    ds_read_b32 v2, v6 offset:24
    s_waitcnt lgkmcnt(0)
    v_readfirstlane_b32 s60, v2
    s_cmp_gt_u32 s60, s70
    s_cbranch_scc0 L_wait
    s_cmp_ge_u32 s60, 0x1000
    s_cbranch_scc1 L_fin
L_go:
    buffer_load_dwordx4 v[224:227], v4, s[44:47], s59 offen offset:0 sc1
    buffer_load_dwordx4 v[228:231], v4, s[44:47], s59 offen offset:1024 sc1
    buffer_load_dwordx4 v[232:235], v4, s[44:47], s59 offen offset:2048 sc1
    buffer_load_dwordx4 v[236:239], v4, s[44:47], s59 offen offset:3072 sc1
    buffer_load_dwordx4 v[240:243], v4, s[44:47], s64 offen offset:0 sc1
    buffer_load_dwordx4 v[244:247], v4, s[44:47], s64 offen offset:1024 sc1
    buffer_load_dwordx4 v[248:251], v4, s[44:47], s64 offen offset:2048 sc1
    buffer_load_dwordx4 v[252:255], v4, s[44:47], s64 offen offset:3072 sc1
L_sum:
    s_waitcnt vmcnt(7)
    v_mfma_f32_16x16x32_bf16 v[12:15], v[8:11], v[224:227], 0
    s_waitcnt vmcnt(6)
    v_mfma_f32_16x16x32_bf16 v[12:15], v[8:11], v[228:231], v[12:15]
    s_waitcnt vmcnt(5)
    v_mfma_f32_16x16x32_bf16 v[12:15], v[8:11], v[232:235], v[12:15]
    s_waitcnt vmcnt(4)
    v_mfma_f32_16x16x32_bf16 v[12:15], v[8:11], v[236:239], v[12:15]
    s_waitcnt vmcnt(3)
    v_mfma_f32_16x16x32_bf16 v[12:15], v[8:11], v[240:243], v[12:15]
    s_waitcnt vmcnt(2)
    v_mfma_f32_16x16x32_bf16 v[12:15], v[8:11], v[244:247], v[12:15]
    s_waitcnt vmcnt(1)
    v_mfma_f32_16x16x32_bf16 v[12:15], v[8:11], v[248:251], v[12:15]
    s_waitcnt vmcnt(0)
    v_mfma_f32_16x16x32_bf16 v[12:15], v[8:11], v[252:255], v[12:15]
    s_add_u32 s70, s70, s71
    s_nop 6
    v_cvt_pk_bf16_f32 v2, v12, v13
    v_cvt_pk_bf16_f32 v3, v14, v15
    buffer_store_dwordx2 v[2:3], v5, s[48:51], s65 offen
    s_cmp_lt_u32 s70, 9
    s_cbranch_scc1 L_chunk
L_piece:
    s_cmp_eq_u32 s58, 0
    s_cbranch_scc1 L_fin
    s_ff1_i32_b32 s57, s58
    s_bitset0_b32 s58, s57
    s_mov_b32 s70, 0
    s_branch L_chunk
L_fin:
    s_endpgm
L_pair:
    s_mul_i32 s70, s57, 9216
    s_add_u32 s65, s69, s70
    s_lshr_b32 s60, s57, 3
    s_lshl_b32 s60, s60, 15
    s_and_b32 s61, s57, 7
    s_lshl_b32 s61, s61, 7
    s_add_u32 s59, s68, s60
    s_add_u32 s59, s59, s61
    s_add_u32 s64, s59, 4096
    s_mul_i32 s70, s10, 3
    s_sub_u32 s70, s70, 3
    s_add_u32 s70, s70, s8
    s_cmp_ge_u32 s70, 9
    s_cselect_b32 s60, 9, 0
    s_sub_u32 s70, s70, s60
    s_lshl_b32 s60, s70, 17
    v_add_u32 v24, s60, v4
    s_lshl_b32 s60, s70, 7
    s_add_u32 s12, s65, s60
    s_add_u32 s70, s70, 1
    s_cmp_ge_u32 s70, 9
    s_cselect_b32 s60, 9, 0
    s_sub_u32 s70, s70, s60
    s_lshl_b32 s60, s70, 17
    v_add_u32 v25, s60, v4
    s_lshl_b32 s60, s70, 7
    s_add_u32 s13, s65, s60
    s_add_u32 s70, s70, 1
    s_cmp_ge_u32 s70, 9
    s_cselect_b32 s60, 9, 0
    s_sub_u32 s70, s70, s60
    s_lshl_b32 s60, s70, 17
    v_add_u32 v26, s60, v4
    s_lshl_b32 s60, s70, 7
    s_add_u32 s14, s65, s60
    s_add_u32 s70, s70, 1
    s_mov_b32 s70, 0xff
L_w2:
    ds_read_b32 v2, v6 offset:4
    s_waitcnt lgkmcnt(0)
    v_readfirstlane_b32 s60, v2
    s_cmp_lt_u32 s60, 4
    s_cbranch_scc1 L_w2
L_w3:
    ds_read_b32 v2, v6 offset:8
    s_waitcnt lgkmcnt(0)
    v_readfirstlane_b32 s60, v2
    s_and_b32 s61, s60, s70
    s_cbranch_scc1 L_new
    s_cmp_lt_u32 s60, 256
    s_cbranch_scc1 L_w3
    s_waitcnt vmcnt(0)
    s_branch L_fin
L_new:
    s_xor_b32 s70, s70, s61
    s_bitcmp0_b32 s61, 0
    s_cbranch_scc1 L_sk0
    s_waitcnt vmcnt(6)
    buffer_load_dwordx4 v[128:131], v24, s[44:47], s59 offen offset:0 sc1
    buffer_load_dwordx4 v[160:163], v25, s[44:47], s59 offen offset:0 sc1
    buffer_load_dwordx4 v[192:195], v26, s[44:47], s59 offen offset:0 sc1
L_sk0:
    s_bitcmp0_b32 s61, 1
    s_cbranch_scc1 L_sk1
    s_waitcnt vmcnt(6)
    buffer_load_dwordx4 v[132:135], v24, s[44:47], s59 offen offset:1024 sc1
    buffer_load_dwordx4 v[164:167], v25, s[44:47], s59 offen offset:1024 sc1
    buffer_load_dwordx4 v[196:199], v26, s[44:47], s59 offen offset:1024 sc1
L_sk1:
    s_bitcmp0_b32 s61, 2
    s_cbranch_scc1 L_sk2
    s_waitcnt vmcnt(6)
    buffer_load_dwordx4 v[136:139], v24, s[44:47], s59 offen offset:2048 sc1
    buffer_load_dwordx4 v[168:171], v25, s[44:47], s59 offen offset:2048 sc1
    buffer_load_dwordx4 v[200:203], v26, s[44:47], s59 offen offset:2048 sc1
L_sk2:
    s_bitcmp0_b32 s61, 3
    s_cbranch_scc1 L_sk3
    s_waitcnt vmcnt(6)
    buffer_load_dwordx4 v[140:143], v24, s[44:47], s59 offen offset:3072 sc1
    buffer_load_dwordx4 v[172:175], v25, s[44:47], s59 offen offset:3072 sc1
    buffer_load_dwordx4 v[204:207], v26, s[44:47], s59 offen offset:3072 sc1
L_sk3:
    s_bitcmp0_b32 s61, 4
    s_cbranch_scc1 L_sk4
    s_waitcnt vmcnt(6)
    buffer_load_dwordx4 v[144:147], v24, s[44:47], s64 offen offset:0 sc1
    buffer_load_dwordx4 v[176:179], v25, s[44:47], s64 offen offset:0 sc1
    buffer_load_dwordx4 v[208:211], v26, s[44:47], s64 offen offset:0 sc1
L_sk4:
    s_bitcmp0_b32 s61, 5
    s_cbranch_scc1 L_sk5
    s_waitcnt vmcnt(6)
    buffer_load_dwordx4 v[148:151], v24, s[44:47], s64 offen offset:1024 sc1
    buffer_load_dwordx4 v[180:183], v25, s[44:47], s64 offen offset:1024 sc1
    buffer_load_dwordx4 v[212:215], v26, s[44:47], s64 offen offset:1024 sc1
L_sk5:
    s_bitcmp0_b32 s61, 6
    s_cbranch_scc1 L_sk6
    s_waitcnt vmcnt(6)
    buffer_load_dwordx4 v[152:155], v24, s[44:47], s64 offen offset:2048 sc1
    buffer_load_dwordx4 v[184:187], v25, s[44:47], s64 offen offset:2048 sc1
    buffer_load_dwordx4 v[216:219], v26, s[44:47], s64 offen offset:2048 sc1
L_sk6:
    s_bitcmp0_b32 s61, 7
    s_cbranch_scc1 L_sk7
    s_waitcnt vmcnt(6)
    buffer_load_dwordx4 v[156:159], v24, s[44:47], s64 offen offset:3072 sc1
    buffer_load_dwordx4 v[188:191], v25, s[44:47], s64 offen offset:3072 sc1
    buffer_load_dwordx4 v[220:223], v26, s[44:47], s64 offen offset:3072 sc1
L_sk7:
    s_cmp_lg_u32 s70, 0
    s_cbranch_scc1 L_w3
L_sum3:
    s_waitcnt vmcnt(0)
    v_mfma_f32_16x16x32_bf16 v[12:15], v[8:11], v[128:131], 0
    v_mfma_f32_16x16x32_bf16 v[16:19], v[8:11], v[160:163], 0
    v_mfma_f32_16x16x32_bf16 v[20:23], v[8:11], v[192:195], 0
    v_mfma_f32_16x16x32_bf16 v[12:15], v[8:11], v[132:135], v[12:15]
    v_mfma_f32_16x16x32_bf16 v[16:19], v[8:11], v[164:167], v[16:19]
    v_mfma_f32_16x16x32_bf16 v[20:23], v[8:11], v[196:199], v[20:23]
    v_mfma_f32_16x16x32_bf16 v[12:15], v[8:11], v[136:139], v[12:15]
    v_mfma_f32_16x16x32_bf16 v[16:19], v[8:11], v[168:171], v[16:19]
    v_mfma_f32_16x16x32_bf16 v[20:23], v[8:11], v[200:203], v[20:23]
    v_mfma_f32_16x16x32_bf16 v[12:15], v[8:11], v[140:143], v[12:15]
    v_mfma_f32_16x16x32_bf16 v[16:19], v[8:11], v[172:175], v[16:19]
    v_mfma_f32_16x16x32_bf16 v[20:23], v[8:11], v[204:207], v[20:23]
    v_mfma_f32_16x16x32_bf16 v[12:15], v[8:11], v[144:147], v[12:15]
    v_mfma_f32_16x16x32_bf16 v[16:19], v[8:11], v[176:179], v[16:19]
    v_mfma_f32_16x16x32_bf16 v[20:23], v[8:11], v[208:211], v[20:23]
    v_mfma_f32_16x16x32_bf16 v[12:15], v[8:11], v[148:151], v[12:15]
    v_mfma_f32_16x16x32_bf16 v[16:19], v[8:11], v[180:183], v[16:19]
    v_mfma_f32_16x16x32_bf16 v[20:23], v[8:11], v[212:215], v[20:23]
    v_mfma_f32_16x16x32_bf16 v[12:15], v[8:11], v[152:155], v[12:15]
    v_mfma_f32_16x16x32_bf16 v[16:19], v[8:11], v[184:187], v[16:19]
    v_mfma_f32_16x16x32_bf16 v[20:23], v[8:11], v[216:219], v[20:23]
    v_mfma_f32_16x16x32_bf16 v[12:15], v[8:11], v[156:159], v[12:15]
    v_mfma_f32_16x16x32_bf16 v[16:19], v[8:11], v[188:191], v[16:19]
    v_mfma_f32_16x16x32_bf16 v[20:23], v[8:11], v[220:223], v[20:23]
    s_nop 3
    s_nop 1
    v_cvt_pk_bf16_f32 v28, v12, v13
    v_cvt_pk_bf16_f32 v29, v14, v15
    buffer_store_dwordx2 v[28:29], v5, s[48:51], s12 offen
    s_nop 1
    v_cvt_pk_bf16_f32 v30, v16, v17
    v_cvt_pk_bf16_f32 v31, v18, v19
    buffer_store_dwordx2 v[30:31], v5, s[48:51], s13 offen
    s_nop 1
    v_cvt_pk_bf16_f32 v32, v20, v21
    v_cvt_pk_bf16_f32 v33, v22, v23
    buffer_store_dwordx2 v[32:33], v5, s[48:51], s14 offen
    s_branch L_fin
L_conf:
    s_mov_b32 s71, 3
    s_waitcnt vmcnt(0) lgkmcnt(0)
    s_barrier
L_find:
L_cfind:
    v_mov_b32 v31, 65536
    s_cmp_eq_u32 s9, 4
    s_cbranch_scc1 L_steal
    s_barrier
    ds_read_b32 v30, v31
    s_waitcnt lgkmcnt(0)
    v_readfirstlane_b32 s60, v30
    v_mov_b32 v30, 0
    v_mov_b32 v31, 0
    s_branch L_redo
L_steal:
    s_lshr_b32 s12, s2, 5
    s_mov_b32 s13, 0
    s_lshl_b32 s15, s12, 5
    s_add_u32 s15, s15, 8
L_sh1:
    s_and_b32 s14, s2, 24
    s_lshr_b32 s16, s70, s14
    s_and_b32 s16, s16, 0xff
    s_bcnt1_i32_b32 s60, s16
    s_cmp_lt_u32 s60, 7
    s_cselect_b32 s61, s13, 99
    s_cmp_ge_u32 s61, 8
    s_cbranch_scc1 L_sh2
    s_mov_b32 s70, 0
    s_atomic_or s70, s[96:97], s15 glc
    s_add_u32 s13, s13, 1
    s_waitcnt lgkmcnt(0)
    s_branch L_sh1
L_sh2:
    s_mov_b32 s13, 0
    s_cmp_eq_u32 s60, 8
    s_cbranch_scc1 L_st2
    s_ff0_i32_b32 s61, s16
    s_add_u32 s14, s14, s61
    s_cmp_eq_u32 s60, 7
    s_cselect_b32 s60, s71, 0
    s_cmp_eq_u32 s60, 2
    s_cbranch_scc0 L_st3
    s_lshl_b32 s60, s12, 5
    s_add_u32 s60, s60, s14
    v_mov_b32 v30, s60
    ds_write_b32 v31, v30
    s_lshl_b32 s70, 1, s14
    s_waitcnt lgkmcnt(0)
    s_atomic_or s70, s[96:97], s15 glc
    s_barrier
    s_branch L_redo
L_st1:
    s_lshl_b32 s15, s12, 5
    s_add_u32 s15, s15, 8
    s_mov_b32 s70, 0
    s_atomic_or s70, s[96:97], s15 glc
    s_waitcnt lgkmcnt(0)
L_st2:
    s_ff0_i32_b32 s14, s70
    s_cmp_lg_u32 s14, -1
    s_cbranch_scc1 L_st3
    s_add_u32 s12, s12, 1
    s_and_b32 s12, s12, 7
    s_add_u32 s13, s13, 1
    s_cmp_lt_u32 s13, 8
    s_cbranch_scc1 L_st1
    s_mov_b32 s60, 256
    s_branch L_st4
L_st3:
    s_lshl_b32 s70, 1, s14
    s_atomic_or s70, s[96:97], s15 glc
    s_waitcnt lgkmcnt(0)
    s_bitcmp1_b32 s70, s14
    s_cbranch_scc1 L_st2
    s_lshl_b32 s60, s12, 5
    s_add_u32 s60, s60, s14
L_st4:
    v_mov_b32 v30, s60
    ds_write_b32 v31, v30
    s_waitcnt lgkmcnt(0)
    s_barrier
L_redo:
    s_xor_b32 s61, s2, s60
    s_mov_b32 s2, s60
    s_cmp_eq_u32 s71, 2
    s_cselect_b32 s61, s61, 8
    s_cmp_lt_u32 s61, 8
    s_cbranch_scc1 L_fix
    s_mov_b32 s71, 1
    s_waitcnt vmcnt(0)
    s_cmp_lt_u32 s2, 256
    s_cbranch_scc1 L_restart
    s_endpgm
L_fix:
    s_and_b32 s60, s2, 7
    s_sub_u32 s61, s60, s8
    s_mov_b32 s12, s8
    s_mov_b32 s8, s60
    s_cmp_lt_u32 s9, 4
    s_cbranch_scc1 L_cgo
    s_cmp_eq_u32 s61, 0
    s_cbranch_scc1 L_fixed
    s_mul_i32 s60, s61, 73728
    s_add_u32 s57, s69, s60
    s_add_u32 s62, s62, s60
    s_lshl_b32 s61, s61, 21
    s_add_u32 s59, s59, s61
    s_add_u32 m0, s22, 32768
    s_nop 0
    buffer_load_dwordx4 v14, s[24:27], s57 offen offset:0  lds
    buffer_load_dwordx4 v15, s[24:27], s57 offen offset:1024  lds
    s_add_u32 s57, s57, 128
    s_cmp_eq_u32 s57, s62
    s_cselect_b32 s60, 1152, 0
    s_sub_u32 s57, s57, s60
    s_add_u32 m0, s22, 40960
    s_nop 0
    buffer_load_dwordx4 v14, s[24:27], s57 offen offset:0  lds
    buffer_load_dwordx4 v15, s[24:27], s57 offen offset:1024  lds
    s_add_u32 s57, s57, 128
    s_cmp_eq_u32 s57, s62
    s_cselect_b32 s60, 1152, 0
    s_sub_u32 s57, s57, s60
    s_waitcnt vmcnt(0)
L_fixed:
    s_and_b32 s12, s12, 3
    s_cmp_eq_u32 s12, 1
    s_cbranch_scc1 L_go1
    s_cmp_eq_u32 s12, 2
    s_cbranch_scc1 L_go2
    s_cmp_eq_u32 s12, 3
    s_cbranch_scc1 L_go3
    s_branch L_go0
L_end:
    s_endpgm
.p2align 6
L_compute:
    s_lshl_b32 s59, s8, 21
    s_lshl_b32 s60, s7, 17
    s_add_u32 s59, s59, s60
    s_mul_i32 s67, s7, 294912
    s_lshl3_add_u32 s63, s6, s8
    s_mul_i32 s63, s63, 1179648
    s_mov_b32 s24, 2097152
    s_mov_b32 s25, 4194304
    s_cmp_lg_u32 s10, 0
    s_waitcnt lgkmcnt(0)
    s_cbranch_scc1 L_stl
    s_load_dword s26, s[18:19], 0
    s_load_dword s27, s[18:19], s24
    s_load_dword s28, s[18:19], s25
    s_load_dword s29, s[14:15], s59
    s_load_dword s30, s[16:17], s59
    s_load_dword s31, s[20:21], s67
    s_load_dword s32, s[98:99], s63
    s_load_dword s33, s[94:95], 0
    s_add_u32 s24, s63, 1179644
    s_mov_b32 s25, 18874368
    s_load_dword s34, s[98:99], s24
    s_load_dword s35, s[98:99], s25
L_stl:
    v_and_b32 v20, 63, v0
    s_lshr_b32 s60, s10, 1
    s_and_b32 s61, s10, 1
    v_lshrrev_b32 v13, 5, v20
    v_bfe_u32 v14, v20, 2, 2
    v_lshlrev_b32 v14, 6, v14
    v_bfe_u32 v15, v20, 4, 1
    v_lshl_add_u32 v14, v15, 5, v14
    v_and_b32 v15, 3, v20
    v_lshl_add_u32 v7, v15, 3, v14
    v_lshl_add_u32 v7, v13, 10, v7
    v_add_u32 v7, 81920, v7
    v_and_b32 v16, 1, v20
    v_bfe_u32 v17, v20, 1, 1
    v_lshl_add_u32 v16, v16, 1, v17
    v_lshl_add_u32 v16, v16, 3, v14
    s_lshl_b32 s63, s60, 13
    v_lshl_add_u32 v2, v13, 11, v16
    v_add_u32 v2, s63, v2
    s_mul_i32 s63, s60, 16640
    v_lshl_add_u32 v16, v13, 9, v16
    v_add_u32 v8, s63, v16
    v_xor_b32 v9, 16384, v8
    v_and_b32 v17, 31, v20
    v_bfe_u32 v18, v20, 2, 2
    v_xor_b32 v18, v18, v13
    v_lshlrev_b32 v18, 4, v18
    s_lshl_b32 s63, s61, 12
    s_add_u32 s63, s63, 32768
    v_bfe_u32 v19, v20, 1, 3
    v_xor_b32 v19, v19, v13
    v_lshlrev_b32 v19, 4, v19
    v_lshl_add_u32 v3, v17, 7, v19
    v_add_u32 v3, s63, v3
    v_xor_b32 v4, 32, v3
    v_lshrrev_b32 v19, 2, v17
    v_lshl_add_u32 v19, v19, 10, v18
    v_and_b32 v17, 3, v17
    v_lshl_add_u32 v19, v17, 6, v19
    v_add_u32 v5, 131072, v19
    v_xor_b32 v6, 32, v5
    v_lshlrev_b32 v19, 4, v20
    s_lshl_b32 s63, s10, 13
    s_add_u32 s63, s63, 65536
    v_add_u32 v10, s63, v19
    v_xor_b32 v11, 16384, v10
    v_bfe_u32 v1, v20, 2, 3
    v_lshlrev_b32 v1, 7, v1
    v_lshrrev_b32 v19, 5, v20
    v_lshl_add_u32 v1, v19, 6, v1
    v_and_b32 v19, 3, v20
    v_lshl_add_u32 v1, v19, 4, v1
    v_lshrrev_b32 v19, 2, v20
    v_xor_b32 v19, v19, v20
    v_bfe_u32 v19, v19, 2, 1
    v_add_u32 v19, -1, v19
    v_and_b32 v244, 0x3f803f80, v19
    v_mov_b32 v245, v244
    v_mov_b32 v246, v244
    v_mov_b32 v247, v244
    s_mov_b32 s66, 0x40004000
    s_mov_b32 s56, 13728285
    s_mov_b32 s57, 267775999
    v_mov_b32 v16, 0
    v_mov_b32 v17, 0
    v_mov_b32 v18, 0
    v_mov_b32 v19, 0
    v_mov_b32 v20, 0
    v_mov_b32 v21, 0
    v_mov_b32 v22, 0
    v_mov_b32 v23, 0
    v_mov_b32 v24, 0
    v_mov_b32 v25, 0
    v_mov_b32 v26, 0
    v_mov_b32 v27, 0
    v_mov_b32 v28, 0
    v_mov_b32 v29, 0
    v_mov_b32 v30, 0
    v_mov_b32 v31, 0
    v_mov_b32 v32, 0
    v_mov_b32 v33, 0
    v_mov_b32 v34, 0
    v_mov_b32 v35, 0
    v_mov_b32 v36, 0
    v_mov_b32 v37, 0
    v_mov_b32 v38, 0
    v_mov_b32 v39, 0
    v_mov_b32 v40, 0
    v_mov_b32 v41, 0
    v_mov_b32 v42, 0
    v_mov_b32 v43, 0
    v_mov_b32 v44, 0
    v_mov_b32 v45, 0
    v_mov_b32 v46, 0
    v_mov_b32 v47, 0
    v_mov_b32 v48, 0
    v_mov_b32 v49, 0
    v_mov_b32 v50, 0
    v_mov_b32 v51, 0
    v_mov_b32 v52, 0
    v_mov_b32 v53, 0
    v_mov_b32 v54, 0
    v_mov_b32 v55, 0
    v_mov_b32 v56, 0
    v_mov_b32 v57, 0
    v_mov_b32 v58, 0
    v_mov_b32 v59, 0
    v_mov_b32 v60, 0
    v_mov_b32 v61, 0
    v_mov_b32 v62, 0
    v_mov_b32 v63, 0
    v_mov_b32 v64, 0
    v_mov_b32 v65, 0
    v_mov_b32 v66, 0
    v_mov_b32 v67, 0
    v_mov_b32 v68, 0
    v_mov_b32 v69, 0
    v_mov_b32 v70, 0
    v_mov_b32 v71, 0
    v_mov_b32 v72, 0
    v_mov_b32 v73, 0
    v_mov_b32 v74, 0
    v_mov_b32 v75, 0
    v_mov_b32 v76, 0
    v_mov_b32 v77, 0
    v_mov_b32 v78, 0
    v_mov_b32 v79, 0
    v_mov_b32 v80, 0
    v_mov_b32 v81, 0
    v_mov_b32 v82, 0
    v_mov_b32 v83, 0
    v_mov_b32 v84, 0
    v_mov_b32 v85, 0
    v_mov_b32 v86, 0
    v_mov_b32 v87, 0
    v_mov_b32 v88, 0
    v_mov_b32 v89, 0
    v_mov_b32 v90, 0
    v_mov_b32 v91, 0
    v_mov_b32 v92, 0
    v_mov_b32 v93, 0
    v_mov_b32 v94, 0
    v_mov_b32 v95, 0
    v_mov_b32 v96, 0
    v_mov_b32 v97, 0
    v_mov_b32 v98, 0
    v_mov_b32 v99, 0
    v_mov_b32 v100, 0
    v_mov_b32 v101, 0
    v_mov_b32 v102, 0
    v_mov_b32 v103, 0
    v_mov_b32 v104, 0
    v_mov_b32 v105, 0
    v_mov_b32 v106, 0
    v_mov_b32 v107, 0
    v_mov_b32 v108, 0
    v_mov_b32 v109, 0
    v_mov_b32 v110, 0
    v_mov_b32 v111, 0
    v_mov_b32 v112, 0
    v_mov_b32 v113, 0
    v_mov_b32 v114, 0
    v_mov_b32 v115, 0
    v_mov_b32 v116, 0
    v_mov_b32 v117, 0
    v_mov_b32 v118, 0
    v_mov_b32 v119, 0
    v_mov_b32 v120, 0
    v_mov_b32 v121, 0
    v_mov_b32 v122, 0
    v_mov_b32 v123, 0
    v_mov_b32 v124, 0
    v_mov_b32 v125, 0
    v_mov_b32 v126, 0
    v_mov_b32 v127, 0
    v_mov_b32 v128, 0
    v_mov_b32 v129, 0
    v_mov_b32 v130, 0
    v_mov_b32 v131, 0
    v_mov_b32 v132, 0
    v_mov_b32 v133, 0
    v_mov_b32 v134, 0
    v_mov_b32 v135, 0
    v_mov_b32 v136, 0
    v_mov_b32 v137, 0
    v_mov_b32 v138, 0
    v_mov_b32 v139, 0
    v_mov_b32 v140, 0
    v_mov_b32 v141, 0
    v_mov_b32 v142, 0
    v_mov_b32 v143, 0
    v_mov_b32 v208, 0
    v_mov_b32 v209, 0
    v_mov_b32 v210, 0
    v_mov_b32 v211, 0
    v_mov_b32 v212, 0
    v_mov_b32 v213, 0
    v_mov_b32 v214, 0
    v_mov_b32 v215, 0
    v_mov_b32 v216, 0
    v_mov_b32 v217, 0
    v_mov_b32 v218, 0
    v_mov_b32 v219, 0
    v_mov_b32 v220, 0
    v_mov_b32 v221, 0
    v_mov_b32 v222, 0
    v_mov_b32 v223, 0
    v_mov_b32 v224, 0
    v_mov_b32 v225, 0
    v_mov_b32 v226, 0
    v_mov_b32 v227, 0
    v_mov_b32 v228, 0
    v_mov_b32 v229, 0
    v_mov_b32 v230, 0
    v_mov_b32 v231, 0
    v_mov_b32 v232, 0
    v_mov_b32 v233, 0
    v_mov_b32 v234, 0
    v_mov_b32 v235, 0
    v_mov_b32 v236, 0
    v_mov_b32 v237, 0
    v_mov_b32 v238, 0
    v_mov_b32 v239, 0
    v_mov_b32 v152, 0
    v_mov_b32 v153, 0
    v_mov_b32 v154, 0
    v_mov_b32 v155, 0
    v_mov_b32 v156, 0
    v_mov_b32 v157, 0
    v_mov_b32 v158, 0
    v_mov_b32 v159, 0
    v_mov_b32 v240, 0
    v_mov_b32 v241, 0
    v_mov_b32 v242, 0
    v_mov_b32 v243, 0
    s_waitcnt lgkmcnt(0)
    s_mov_b32 s48, s94
    s_mov_b32 s49, s95
    s_mov_b32 s50, 1179648
    s_mov_b32 s51, 0x20000
    s_mov_b32 s52, s96
    s_mov_b32 s53, s97
    s_mov_b32 s54, 256
    s_mov_b32 s55, 0x20000
    s_mov_b32 s44, s98
    s_mov_b32 s45, s99
    s_mov_b32 s46, 18911232
    s_mov_b32 s47, 0x20000
    s_mov_b32 s62, 0
    v_mov_b32 v14, 65536
    s_cmp_eq_u32 s71, 2
    s_cbranch_scc1 L_cfind
L_cgo:
    s_lshl_b32 s69, s6, 3
    s_add_u32 s69, s69, s8
    s_mul_i32 s69, s69, 1179648
    s_lshl_b32 s61, s10, 15
    s_add_u32 s69, s69, s61
    s_lshl_b32 s61, s7, 10
    s_add_u32 s69, s69, s61
    s_add_u32 s71, s69, 1179648
    s_lshl_b32 s61, s8, 17
    s_add_u32 s69, s69, s61
    s_sub_u32 s69, s69, 131072
    s_lshl3_add_u32 s63, s6, s8
    s_mul_i32 s63, s63, 2304
    s_add_u32 s63, s63, 18874368
    s_and_b32 s60, s7, 7
    s_lshl4_add_u32 s63, s60, s63
    s_lshr_b32 s60, s7, 3
    s_lshl3_add_u32 s63, s60, s63
    s_lshr_b32 s60, s10, 1
    s_lshl2_add_u32 s63, s60, s63
    s_and_b32 s60, s10, 1
    s_lshl_b32 s60, s60, 10
    s_add_u32 s63, s63, s60
    v_and_b32 v13, 63, v0
    v_lshrrev_b32 v14, 2, v13
    v_lshlrev_b32 v14, 25, v14
    v_bfe_u32 v15, v13, 3, 2
    v_lshl_add_u32 v14, v15, 11, v14
    v_and_b32 v13, 7, v13
    v_lshl_add_u32 v14, v13, 8, v14
    v_add_u32 v12, s63, v14
    v_mov_b32 v14, 40960
L_q:
    s_barrier
    v_mfma_f32_32x32x16_bf16 v[80:95], v[208:211], v[152:155], v[80:95]
    ds_read_b128 v[144:147], v3 offset:0
    ds_read_b64_tr_b16 v[176:177], v2 offset:0
    ds_read_b64_tr_b16 v[178:179], v2 offset:1024
    v_mfma_f32_32x32x16_bf16 v[96:111], v[212:215], v[152:155], v[96:111]
    ds_read_b64_tr_b16 v[180:181], v2 offset:256
    ds_read_b64_tr_b16 v[182:183], v2 offset:1280
    ds_read_b64_tr_b16 v[184:185], v2 offset:512
    v_mfma_f32_32x32x16_bf16 v[112:127], v[216:219], v[152:155], v[112:127]
    ds_read_b64_tr_b16 v[186:187], v2 offset:1536
    ds_read_b64_tr_b16 v[188:189], v2 offset:768
    ds_read_b64_tr_b16 v[190:191], v2 offset:1792
    v_mfma_f32_32x32x16_bf16 v[128:143], v[220:223], v[152:155], v[128:143]
    ds_read_b128 v[148:151], v4 offset:0
    ds_read_b64_tr_b16 v[192:193], v2 offset:4096
    ds_read_b64_tr_b16 v[194:195], v2 offset:5120
    v_mfma_f32_32x32x16_bf16 v[80:95], v[224:227], v[156:159], v[80:95]
    ds_read_b64_tr_b16 v[196:197], v2 offset:4352
    ds_read_b64_tr_b16 v[198:199], v2 offset:5376
    ds_read_b64_tr_b16 v[200:201], v2 offset:4608
    v_mfma_f32_32x32x16_bf16 v[96:111], v[228:231], v[156:159], v[96:111]
    ds_read_b64_tr_b16 v[202:203], v2 offset:5632
    ds_read_b64_tr_b16 v[204:205], v2 offset:4864
    ds_read_b64_tr_b16 v[206:207], v2 offset:5888
    v_mfma_f32_32x32x16_bf16 v[112:127], v[232:235], v[156:159], v[112:127]
    v_xor_b32 v3, 64, v3
    v_xor_b32 v4, 64, v4
    v_mfma_f32_32x32x16_bf16 v[128:143], v[236:239], v[156:159], v[128:143]
    s_waitcnt lgkmcnt(0)
    s_barrier
    v_mfma_f32_32x32x16_bf16 v[80:95], v[176:179], v[144:147], v[80:95]
    ds_read_b128 v[152:155], v3 offset:0
    ds_read_b64_tr_b16 v[208:209], v2 offset:16384
    ds_read_b64_tr_b16 v[210:211], v2 offset:17408
    v_mfma_f32_32x32x16_bf16 v[96:111], v[180:183], v[144:147], v[96:111]
    ds_read_b64_tr_b16 v[212:213], v2 offset:16640
    ds_read_b64_tr_b16 v[214:215], v2 offset:17664
    ds_read_b64_tr_b16 v[216:217], v2 offset:16896
    v_mfma_f32_32x32x16_bf16 v[112:127], v[184:187], v[144:147], v[112:127]
    ds_read_b64_tr_b16 v[218:219], v2 offset:17920
    ds_read_b64_tr_b16 v[220:221], v2 offset:17152
    ds_read_b64_tr_b16 v[222:223], v2 offset:18176
    v_mfma_f32_32x32x16_bf16 v[128:143], v[188:191], v[144:147], v[128:143]
    ds_read_b128 v[156:159], v4 offset:0
    ds_read_b64_tr_b16 v[224:225], v2 offset:20480
    ds_read_b64_tr_b16 v[226:227], v2 offset:21504
    v_mfma_f32_32x32x16_bf16 v[80:95], v[192:195], v[148:151], v[80:95]
    ds_read_b64_tr_b16 v[228:229], v2 offset:20736
    ds_read_b64_tr_b16 v[230:231], v2 offset:21760
    ds_read_b64_tr_b16 v[232:233], v2 offset:20992
    v_mfma_f32_32x32x16_bf16 v[96:111], v[196:199], v[148:151], v[96:111]
    ds_read_b64_tr_b16 v[234:235], v2 offset:22016
    ds_read_b64_tr_b16 v[236:237], v2 offset:21248
    ds_read_b64_tr_b16 v[238:239], v2 offset:22272
    v_mfma_f32_32x32x16_bf16 v[112:127], v[200:203], v[148:151], v[112:127]
    ds_read_b32 v13, v14
    v_xor_b32 v3, 8256, v3
    v_xor_b32 v4, 8256, v4
    v_xor_b32 v2, 49152, v2
    s_add_u32 s62, s62, 1
    s_cmp_lt_u32 s62, 9
    v_mfma_f32_32x32x16_bf16 v[128:143], v[204:207], v[148:151], v[128:143]
    s_waitcnt lgkmcnt(0)
    s_cbranch_scc1 L_q
    v_readfirstlane_b32 s60, v13
    s_cmp_lg_u32 s60, 0
    s_cbranch_scc1 L_conf
    s_barrier
    s_mov_b32 s60, 0x3e0293ee
    s_mov_b32 s64, 16384
    v_mfma_f32_32x32x16_bf16 v[80:95], v[208:211], v[152:155], v[80:95]
    v_mfma_f32_32x32x16_bf16 v[80:95], v[224:227], v[156:159], v[80:95]
    ds_read_b128 v[176:179], v5 offset:0
    ds_read_b128 v[180:183], v6 offset:0
    ds_read_b128 v[184:187], v5 offset:256
    v_mfma_f32_32x32x16_bf16 v[96:111], v[212:215], v[152:155], v[96:111]
    ds_read_b128 v[188:191], v6 offset:256
    ds_read_b128 v[192:195], v5 offset:512
    ds_read_b128 v[196:199], v6 offset:512
    v_mfma_f32_32x32x16_bf16 v[96:111], v[228:231], v[156:159], v[96:111]
    ds_read_b128 v[200:203], v5 offset:768
    ds_read_b128 v[204:207], v6 offset:768
    v_mfma_f32_32x32x16_bf16 v[112:127], v[216:219], v[152:155], v[112:127]
    s_nop 0
    v_mul_f32 v80, s60, v80
    v_mul_f32 v81, s60, v81
    v_mul_f32 v82, s60, v82
    v_mul_f32 v83, s60, v83
    v_cvt_pk_bf16_f32 v144, v80, v81
    v_mfma_f32_32x32x16_bf16 v[112:127], v[232:235], v[156:159], v[112:127]
    v_cvt_pk_bf16_f32 v145, v82, v83
    v_mul_f32 v84, s60, v84
    v_mul_f32 v85, s60, v85
    v_mul_f32 v86, s60, v86
    v_mul_f32 v87, s60, v87
    v_cvt_pk_bf16_f32 v146, v84, v85
    v_mfma_f32_32x32x16_bf16 v[128:143], v[220:223], v[152:155], v[128:143]
    v_cvt_pk_bf16_f32 v147, v86, v87
    v_mul_f32 v88, s60, v88
    v_mul_f32 v89, s60, v89
    v_mul_f32 v90, s60, v90
    v_mul_f32 v91, s60, v91
    v_cvt_pk_bf16_f32 v148, v88, v89
    v_mfma_f32_32x32x16_bf16 v[128:143], v[236:239], v[156:159], v[128:143]
    v_cvt_pk_bf16_f32 v149, v90, v91
    v_mul_f32 v92, s60, v92
    v_mul_f32 v93, s60, v93
    v_mul_f32 v94, s60, v94
    v_mul_f32 v95, s60, v95
    v_cvt_pk_bf16_f32 v150, v92, v93
    v_cvt_pk_bf16_f32 v151, v94, v95
    s_nop 1
    v_mul_f32 v96, s60, v96
    v_mul_f32 v97, s60, v97
    v_mul_f32 v98, s60, v98
    v_mul_f32 v99, s60, v99
    v_cvt_pk_bf16_f32 v152, v96, v97
    v_cvt_pk_bf16_f32 v153, v98, v99
    v_mul_f32 v100, s60, v100
    v_mul_f32 v101, s60, v101
    v_mul_f32 v102, s60, v102
    v_mul_f32 v103, s60, v103
    v_cvt_pk_bf16_f32 v154, v100, v101
    v_cvt_pk_bf16_f32 v155, v102, v103
    v_mul_f32 v104, s60, v104
    v_mul_f32 v105, s60, v105
    v_mul_f32 v106, s60, v106
    v_mul_f32 v107, s60, v107
    v_cvt_pk_bf16_f32 v156, v104, v105
    v_cvt_pk_bf16_f32 v157, v106, v107
    v_mul_f32 v108, s60, v108
    v_mul_f32 v109, s60, v109
    v_mul_f32 v110, s60, v110
    v_mul_f32 v111, s60, v111
    v_cvt_pk_bf16_f32 v158, v108, v109
    v_cvt_pk_bf16_f32 v159, v110, v111
    s_waitcnt lgkmcnt(0)
    v_mfma_f32_32x32x16_bf16 v[80:95], v[176:179], v[144:147], 0
    v_mul_f32 v112, s60, v112
    v_mul_f32 v113, s60, v113
    v_mul_f32 v114, s60, v114
    v_mul_f32 v115, s60, v115
    v_cvt_pk_bf16_f32 v160, v112, v113
    v_cvt_pk_bf16_f32 v161, v114, v115
    v_mfma_f32_32x32x16_bf16 v[80:95], v[180:183], v[148:151], v[80:95]
    v_mul_f32 v116, s60, v116
    v_mul_f32 v117, s60, v117
    v_mul_f32 v118, s60, v118
    v_mul_f32 v119, s60, v119
    v_cvt_pk_bf16_f32 v162, v116, v117
    v_cvt_pk_bf16_f32 v163, v118, v119
    v_mfma_f32_32x32x16_bf16 v[80:95], v[184:187], v[152:155], v[80:95]
    v_mul_f32 v120, s60, v120
    v_mul_f32 v121, s60, v121
    v_mul_f32 v122, s60, v122
    v_mul_f32 v123, s60, v123
    v_cvt_pk_bf16_f32 v164, v120, v121
    v_cvt_pk_bf16_f32 v165, v122, v123
    v_mfma_f32_32x32x16_bf16 v[80:95], v[188:191], v[156:159], v[80:95]
    v_mul_f32 v124, s60, v124
    v_mul_f32 v125, s60, v125
    v_mul_f32 v126, s60, v126
    v_mul_f32 v127, s60, v127
    v_cvt_pk_bf16_f32 v166, v124, v125
    v_cvt_pk_bf16_f32 v167, v126, v127
    s_nop 0
    v_mfma_f32_32x32x16_bf16 v[80:95], v[192:195], v[160:163], v[80:95]
    v_mul_f32 v128, s60, v128
    v_mul_f32 v129, s60, v129
    v_mul_f32 v130, s60, v130
    v_mul_f32 v131, s60, v131
    v_cvt_pk_bf16_f32 v168, v128, v129
    v_cvt_pk_bf16_f32 v169, v130, v131
    v_mfma_f32_32x32x16_bf16 v[80:95], v[196:199], v[164:167], v[80:95]
    v_mul_f32 v132, s60, v132
    v_mul_f32 v133, s60, v133
    v_mul_f32 v134, s60, v134
    v_mul_f32 v135, s60, v135
    v_cvt_pk_bf16_f32 v170, v132, v133
    v_cvt_pk_bf16_f32 v171, v134, v135
    v_mul_f32 v136, s60, v136
    v_mul_f32 v137, s60, v137
    v_mul_f32 v138, s60, v138
    v_mul_f32 v139, s60, v139
    v_cvt_pk_bf16_f32 v172, v136, v137
    v_cvt_pk_bf16_f32 v173, v138, v139
    v_mul_f32 v140, s60, v140
    v_mul_f32 v141, s60, v141
    v_mul_f32 v142, s60, v142
    v_mul_f32 v143, s60, v143
    v_cvt_pk_bf16_f32 v174, v140, v141
    v_cvt_pk_bf16_f32 v175, v142, v143
    s_nop 0
    v_mfma_f32_32x32x16_bf16 v[80:95], v[200:203], v[168:171], v[80:95]
    ds_read_b128 v[176:179], v5 offset:8192
    ds_read_b128 v[180:183], v6 offset:8192
    ds_read_b128 v[184:187], v5 offset:8448
    ds_read_b128 v[188:191], v6 offset:8448
    ds_read_b128 v[192:195], v5 offset:8704
    ds_read_b128 v[196:199], v6 offset:8704
    v_mfma_f32_32x32x16_bf16 v[80:95], v[204:207], v[172:175], v[80:95]
    ds_read_b128 v[200:203], v5 offset:8960
    ds_read_b128 v[204:207], v6 offset:8960
    s_waitcnt lgkmcnt(5)
    v_mfma_f32_32x32x16_bf16 v[96:111], v[176:179], v[144:147], 0
    v_add_u32 v5, s64, v5
    v_add_u32 v6, s64, v6
    v_mfma_f32_32x32x16_bf16 v[96:111], v[180:183], v[148:151], v[96:111]
    s_nop 3
    v_mfma_f32_32x32x16_bf16 v[96:111], v[184:187], v[152:155], v[96:111]
    v_max3_f32 v253, v80, v81, v82
    v_max3_f32 v254, v83, v84, v85
    v_max3_f32 v253, v253, v86, v87
    v_max3_f32 v254, v254, v88, v89
    v_max3_f32 v253, v253, v90, v91
    s_waitcnt lgkmcnt(0)
    v_mfma_f32_32x32x16_bf16 v[96:111], v[188:191], v[156:159], v[96:111]
    v_max3_f32 v254, v254, v92, v93
    v_max3_f32 v253, v253, v94, v95
    v_max_f32 v253, v253, v254
    v_mov_b32 v254, v253
    s_nop 1
    v_mfma_f32_32x32x16_bf16 v[96:111], v[192:195], v[160:163], v[96:111]
    v_permlane32_swap_b32 v254, v253
    s_nop 0
    v_max_f32 v253, v253, v254
    v_sub_f32 v128, 0xc1700000, v253
    v_add_f32 v80, v80, v128
    v_add_f32 v81, v81, v128
    v_mfma_f32_32x32x16_bf16 v[96:111], v[196:199], v[164:167], v[96:111]
    v_add_f32 v82, v82, v128
    v_add_f32 v83, v83, v128
    v_add_f32 v84, v84, v128
    v_add_f32 v85, v85, v128
    v_add_f32 v86, v86, v128
    v_add_f32 v87, v87, v128
    v_mfma_f32_32x32x16_bf16 v[96:111], v[200:203], v[168:171], v[96:111]
    v_add_f32 v88, v88, v128
    v_add_f32 v89, v89, v128
    v_add_f32 v90, v90, v128
    v_add_f32 v91, v91, v128
    v_add_f32 v92, v92, v128
    v_add_f32 v93, v93, v128
    v_mfma_f32_32x32x16_bf16 v[96:111], v[204:207], v[172:175], v[96:111]
    v_add_f32 v94, v94, v128
    v_add_f32 v95, v95, v128
    v_mov_b32 v129, v128
    v_mov_b32 v130, v128
    v_mov_b32 v131, v128
    v_mov_b32 v132, v128
    v_mov_b32 v133, v128
    v_mov_b32 v134, v128
    v_mov_b32 v135, v128
    v_mov_b32 v136, v128
    v_mov_b32 v137, v128
    v_mov_b32 v138, v128
    v_mov_b32 v139, v128
    v_mov_b32 v140, v128
    v_mov_b32 v141, v128
    v_mov_b32 v142, v128
    v_mov_b32 v143, v128
    s_barrier
    ds_read_b128 v[176:179], v5 offset:0
    v_exp_f32 v248, v80
    v_exp_f32 v249, v81
    ds_read_b128 v[180:183], v6 offset:0
    v_exp_f32 v250, v82
    v_cvt_pk_bf16_f32 v112, v248, v249
    ds_read_b128 v[184:187], v5 offset:256
    v_exp_f32 v251, v83
    v_exp_f32 v248, v84
    ds_read_b128 v[188:191], v6 offset:256
    v_cvt_pk_bf16_f32 v113, v250, v251
    v_exp_f32 v249, v85
    ds_read_b128 v[192:195], v5 offset:512
    v_exp_f32 v250, v86
    v_cvt_pk_bf16_f32 v114, v248, v249
    ds_read_b128 v[196:199], v6 offset:512
    v_exp_f32 v251, v87
    v_or3_b32 v252, v112, v113, v114
    ds_read_b128 v[200:203], v5 offset:768
    v_exp_f32 v248, v88
    v_cvt_pk_bf16_f32 v115, v250, v251
    ds_read_b128 v[204:207], v6 offset:768
    v_exp_f32 v249, v89
    v_exp_f32 v250, v90
    v_cvt_pk_bf16_f32 v116, v248, v249
    v_exp_f32 v251, v91
    v_or3_b32 v252, v252, v115, v116
    v_exp_f32 v248, v92
    v_cvt_pk_bf16_f32 v117, v250, v251
    v_exp_f32 v249, v93
    v_exp_f32 v250, v94
    v_cvt_pk_bf16_f32 v118, v248, v249
    v_exp_f32 v251, v95
    v_or3_b32 v252, v252, v117, v118
    v_cvt_pk_bf16_f32 v119, v250, v251
    v_bitop3_b32 v252, v252, v119, s66 bitop3:0xa8
    v_cmp_ne_u32 vcc, 0, v252
    v_add_f32 v96, v96, v128
    v_add_f32 v97, v97, v128
    v_add_f32 v98, v98, v128
    v_add_f32 v99, v99, v128
    v_add_f32 v100, v100, v128
    v_add_f32 v101, v101, v128
    v_add_f32 v102, v102, v128
    v_add_f32 v103, v103, v128
    v_add_f32 v104, v104, v128
    v_add_f32 v105, v105, v128
    v_add_f32 v106, v106, v128
    v_add_f32 v107, v107, v128
    v_add_f32 v108, v108, v128
    v_add_f32 v109, v109, v128
    v_add_f32 v110, v110, v128
    v_add_f32 v111, v111, v128
    s_mov_b32 s62, 0
    s_waitcnt lgkmcnt(0)
L_a:
    v_mfma_f32_32x32x16_bf16 v[80:95], v[176:179], v[144:147], v[128:143]
    ds_read_b64_tr_b16 v[208:209], v7 offset:0
    ds_read_b64_tr_b16 v[210:211], v7 offset:2048
    ds_read_b64_tr_b16 v[212:213], v7 offset:256
    v_exp_f32 v248, v96
    v_mfma_f32_32x32x16_bf16 v[80:95], v[180:183], v[148:151], v[80:95]
    ds_read_b64_tr_b16 v[214:215], v7 offset:2304
    ds_read_b64_tr_b16 v[216:217], v7 offset:512
    ds_read_b64_tr_b16 v[218:219], v7 offset:2560
    v_exp_f32 v249, v97
    v_mfma_f32_32x32x16_bf16 v[80:95], v[184:187], v[152:155], v[80:95]
    ds_read_b64_tr_b16 v[220:221], v7 offset:768
    ds_read_b64_tr_b16 v[222:223], v7 offset:2816
    ds_read_b64_tr_b16 v[224:225], v7 offset:4096
    v_exp_f32 v250, v98
    v_cvt_pk_bf16_f32 v120, v248, v249
    v_mfma_f32_32x32x16_bf16 v[80:95], v[188:191], v[156:159], v[80:95]
    ds_read_b64_tr_b16 v[226:227], v7 offset:6144
    ds_read_b64_tr_b16 v[228:229], v7 offset:4352
    ds_read_b64_tr_b16 v[230:231], v7 offset:6400
    v_exp_f32 v251, v99
    v_mfma_f32_32x32x16_bf16 v[80:95], v[192:195], v[160:163], v[80:95]
    ds_read_b64_tr_b16 v[232:233], v7 offset:4608
    ds_read_b64_tr_b16 v[234:235], v7 offset:6656
    v_exp_f32 v248, v100
    v_cvt_pk_bf16_f32 v121, v250, v251
    v_mfma_f32_32x32x16_bf16 v[80:95], v[196:199], v[164:167], v[80:95]
    ds_read_b64_tr_b16 v[236:237], v7 offset:4864
    ds_read_b64_tr_b16 v[238:239], v7 offset:6912
    v_exp_f32 v249, v101
    v_exp_f32 v250, v102
    v_mfma_f32_32x32x16_bf16 v[80:95], v[200:203], v[168:171], v[80:95]
    v_cvt_pk_bf16_f32 v122, v248, v249
    v_exp_f32 v251, v103
    v_or3_b32 v252, v120, v121, v122
    v_exp_f32 v248, v104
    v_mfma_f32_32x32x16_bf16 v[80:95], v[204:207], v[172:175], v[80:95]
    v_cvt_pk_bf16_f32 v123, v250, v251
    v_exp_f32 v249, v105
    v_exp_f32 v250, v106
    s_waitcnt lgkmcnt(0)
    v_mfma_f32_32x32x16_bf16 v[16:31], v[208:211], v[112:115], v[16:31]
    ds_read_b128 v[176:179], v5 offset:8192
    ds_read_b128 v[180:183], v6 offset:8192
    v_cvt_pk_bf16_f32 v124, v248, v249
    v_exp_f32 v251, v107
    v_or3_b32 v252, v252, v123, v124
    v_mfma_f32_32x32x16_bf16 v[32:47], v[212:215], v[112:115], v[32:47]
    ds_read_b128 v[184:187], v5 offset:8448
    ds_read_b128 v[188:191], v6 offset:8448
    v_exp_f32 v248, v108
    v_cvt_pk_bf16_f32 v125, v250, v251
    v_mfma_f32_32x32x16_bf16 v[48:63], v[216:219], v[112:115], v[48:63]
    ds_read_b128 v[192:195], v5 offset:8704
    ds_read_b128 v[196:199], v6 offset:8704
    v_exp_f32 v249, v109
    v_exp_f32 v250, v110
    v_mfma_f32_32x32x16_bf16 v[64:79], v[220:223], v[112:115], v[64:79]
    ds_read_b128 v[200:203], v5 offset:8960
    ds_read_b128 v[204:207], v6 offset:8960
    v_cvt_pk_bf16_f32 v126, v248, v249
    v_exp_f32 v251, v111
    v_or3_b32 v252, v252, v125, v126
    v_mfma_f32_16x16x32_bf16 v[240:243], v[244:247], v[112:115], v[240:243]
    v_cvt_pk_bf16_f32 v127, v250, v251
    v_bitop3_b32 v252, v252, v127, s66 bitop3:0xa8
    v_mfma_f32_32x32x16_bf16 v[16:31], v[224:227], v[116:119], v[16:31]
    v_cmp_ne_u32 vcc, 0, v252
    s_bfe_i32 s64, s56, 0x40000
    s_lshl_b32 s64, s64, 14
    s_lshr_b32 s56, s56, 4
    s_bfe_i32 s65, s57, 0x40000
    s_lshl_b32 s65, s65, 14
    v_mfma_f32_32x32x16_bf16 v[32:47], v[228:231], v[116:119], v[32:47]
    s_lshr_b32 s57, s57, 4
    v_add_u32 v5, s64, v5
    v_add_u32 v6, s64, v6
    v_mfma_f32_32x32x16_bf16 v[48:63], v[232:235], v[116:119], v[48:63]
    v_mfma_f32_32x32x16_bf16 v[64:79], v[236:239], v[116:119], v[64:79]
    v_mfma_f32_16x16x32_bf16 v[240:243], v[244:247], v[116:119], v[240:243]
    s_waitcnt lgkmcnt(0)
    s_cbranch_vccnz L_tr1a
L_ret1a:
    v_mfma_f32_32x32x16_bf16 v[96:111], v[176:179], v[144:147], v[128:143]
    ds_read_b64_tr_b16 v[208:209], v7 offset:8192
    ds_read_b64_tr_b16 v[210:211], v7 offset:10240
    ds_read_b64_tr_b16 v[212:213], v7 offset:8448
    v_exp_f32 v248, v80
    v_mfma_f32_32x32x16_bf16 v[96:111], v[180:183], v[148:151], v[96:111]
    ds_read_b64_tr_b16 v[214:215], v7 offset:10496
    ds_read_b64_tr_b16 v[216:217], v7 offset:8704
    ds_read_b64_tr_b16 v[218:219], v7 offset:10752
    v_exp_f32 v249, v81
    v_mfma_f32_32x32x16_bf16 v[96:111], v[184:187], v[152:155], v[96:111]
    ds_read_b64_tr_b16 v[220:221], v7 offset:8960
    ds_read_b64_tr_b16 v[222:223], v7 offset:11008
    ds_read_b64_tr_b16 v[224:225], v7 offset:12288
    v_exp_f32 v250, v82
    v_cvt_pk_bf16_f32 v112, v248, v249
    v_mfma_f32_32x32x16_bf16 v[96:111], v[188:191], v[156:159], v[96:111]
    ds_read_b64_tr_b16 v[226:227], v7 offset:14336
    ds_read_b64_tr_b16 v[228:229], v7 offset:12544
    ds_read_b64_tr_b16 v[230:231], v7 offset:14592
    v_exp_f32 v251, v83
    v_mfma_f32_32x32x16_bf16 v[96:111], v[192:195], v[160:163], v[96:111]
    ds_read_b64_tr_b16 v[232:233], v7 offset:12800
    ds_read_b64_tr_b16 v[234:235], v7 offset:14848
    v_exp_f32 v248, v84
    v_cvt_pk_bf16_f32 v113, v250, v251
    v_mfma_f32_32x32x16_bf16 v[96:111], v[196:199], v[164:167], v[96:111]
    ds_read_b64_tr_b16 v[236:237], v7 offset:13056
    ds_read_b64_tr_b16 v[238:239], v7 offset:15104
    v_exp_f32 v249, v85
    v_exp_f32 v250, v86
    v_mfma_f32_32x32x16_bf16 v[96:111], v[200:203], v[168:171], v[96:111]
    v_add_u32 v7, s65, v7
    s_add_u32 s62, s62, 1
    s_cmp_eq_u32 s62, 7
    v_cvt_pk_bf16_f32 v114, v248, v249
    v_exp_f32 v251, v87
    v_mfma_f32_32x32x16_bf16 v[96:111], v[204:207], v[172:175], v[96:111]
    v_or3_b32 v252, v112, v113, v114
    v_exp_f32 v248, v88
    s_waitcnt lgkmcnt(0)
    s_barrier
    s_cbranch_scc1 L_alast
    v_mfma_f32_32x32x16_bf16 v[16:31], v[208:211], v[120:123], v[16:31]
    ds_read_b128 v[176:179], v5 offset:0
    ds_read_b128 v[180:183], v6 offset:0
    v_cvt_pk_bf16_f32 v115, v250, v251
    v_exp_f32 v249, v89
    v_mfma_f32_32x32x16_bf16 v[32:47], v[212:215], v[120:123], v[32:47]
    ds_read_b128 v[184:187], v5 offset:256
    ds_read_b128 v[188:191], v6 offset:256
    v_exp_f32 v250, v90
    v_cvt_pk_bf16_f32 v116, v248, v249
    v_mfma_f32_32x32x16_bf16 v[48:63], v[216:219], v[120:123], v[48:63]
    ds_read_b128 v[192:195], v5 offset:512
    ds_read_b128 v[196:199], v6 offset:512
    v_exp_f32 v251, v91
    v_or3_b32 v252, v252, v115, v116
    v_mfma_f32_32x32x16_bf16 v[64:79], v[220:223], v[120:123], v[64:79]
    ds_read_b128 v[200:203], v5 offset:768
    ds_read_b128 v[204:207], v6 offset:768
    v_exp_f32 v248, v92
    v_cvt_pk_bf16_f32 v117, v250, v251
    v_mfma_f32_16x16x32_bf16 v[240:243], v[244:247], v[120:123], v[240:243]
    v_exp_f32 v249, v93
    v_mfma_f32_32x32x16_bf16 v[16:31], v[224:227], v[124:127], v[16:31]
    v_exp_f32 v250, v94
    v_cvt_pk_bf16_f32 v118, v248, v249
    v_exp_f32 v251, v95
    v_or3_b32 v252, v252, v117, v118
    v_mfma_f32_32x32x16_bf16 v[32:47], v[228:231], v[124:127], v[32:47]
    v_cvt_pk_bf16_f32 v119, v250, v251
    v_bitop3_b32 v252, v252, v119, s66 bitop3:0xa8
    v_cmp_ne_u32 vcc, 0, v252
    v_mfma_f32_32x32x16_bf16 v[48:63], v[232:235], v[124:127], v[48:63]
    v_mfma_f32_32x32x16_bf16 v[64:79], v[236:239], v[124:127], v[64:79]
    v_mfma_f32_16x16x32_bf16 v[240:243], v[244:247], v[124:127], v[240:243]
    s_waitcnt lgkmcnt(0)
    s_cbranch_vccnz L_tr0a
L_ret0a:
    s_branch L_a
L_alast:
    v_mfma_f32_32x32x16_bf16 v[16:31], v[208:211], v[120:123], v[16:31]
    ds_read_b64_tr_b16 v[176:177], v7 offset:0
    ds_read_b64_tr_b16 v[178:179], v7 offset:2048
    ds_read_b64_tr_b16 v[180:181], v7 offset:256
    v_cvt_pk_bf16_f32 v115, v250, v251
    v_exp_f32 v249, v89
    v_mfma_f32_32x32x16_bf16 v[32:47], v[212:215], v[120:123], v[32:47]
    ds_read_b64_tr_b16 v[182:183], v7 offset:2304
    ds_read_b64_tr_b16 v[184:185], v7 offset:512
    ds_read_b64_tr_b16 v[186:187], v7 offset:2560
    v_exp_f32 v250, v90
    v_cvt_pk_bf16_f32 v116, v248, v249
    v_mfma_f32_32x32x16_bf16 v[48:63], v[216:219], v[120:123], v[48:63]
    ds_read_b64_tr_b16 v[188:189], v7 offset:768
    ds_read_b64_tr_b16 v[190:191], v7 offset:2816
    ds_read_b64_tr_b16 v[192:193], v7 offset:4096
    v_exp_f32 v251, v91
    v_or3_b32 v252, v252, v115, v116
    v_mfma_f32_32x32x16_bf16 v[64:79], v[220:223], v[120:123], v[64:79]
    ds_read_b64_tr_b16 v[194:195], v7 offset:6144
    ds_read_b64_tr_b16 v[196:197], v7 offset:4352
    ds_read_b64_tr_b16 v[198:199], v7 offset:6400
    v_exp_f32 v248, v92
    v_cvt_pk_bf16_f32 v117, v250, v251
    v_mfma_f32_16x16x32_bf16 v[240:243], v[244:247], v[120:123], v[240:243]
    v_exp_f32 v249, v93
    v_mfma_f32_32x32x16_bf16 v[16:31], v[224:227], v[124:127], v[16:31]
    ds_read_b64_tr_b16 v[200:201], v7 offset:4608
    ds_read_b64_tr_b16 v[202:203], v7 offset:6656
    v_exp_f32 v250, v94
    v_cvt_pk_bf16_f32 v118, v248, v249
    v_mfma_f32_32x32x16_bf16 v[32:47], v[228:231], v[124:127], v[32:47]
    ds_read_b64_tr_b16 v[204:205], v7 offset:4864
    ds_read_b64_tr_b16 v[206:207], v7 offset:6912
    v_exp_f32 v251, v95
    v_or3_b32 v252, v252, v117, v118
    v_cvt_pk_bf16_f32 v119, v250, v251
    v_mfma_f32_32x32x16_bf16 v[48:63], v[232:235], v[124:127], v[48:63]
    v_bitop3_b32 v252, v252, v119, s66 bitop3:0xa8
    v_cmp_ne_u32 vcc, 0, v252
    v_mfma_f32_32x32x16_bf16 v[64:79], v[236:239], v[124:127], v[64:79]
    v_mfma_f32_16x16x32_bf16 v[240:243], v[244:247], v[124:127], v[240:243]
    s_waitcnt lgkmcnt(0)
    s_cbranch_vccnz L_tr0b
L_ret0b:
    v_mfma_f32_32x32x16_bf16 v[16:31], v[176:179], v[112:115], v[16:31]
    ds_read_b64_tr_b16 v[208:209], v7 offset:8192
    ds_read_b64_tr_b16 v[210:211], v7 offset:10240
    v_exp_f32 v248, v96
    v_exp_f32 v249, v97
    v_mfma_f32_32x32x16_bf16 v[32:47], v[180:183], v[112:115], v[32:47]
    ds_read_b64_tr_b16 v[224:225], v7 offset:12288
    ds_read_b64_tr_b16 v[226:227], v7 offset:14336
    v_exp_f32 v250, v98
    v_cvt_pk_bf16_f32 v120, v248, v249
    v_mfma_f32_32x32x16_bf16 v[48:63], v[184:187], v[112:115], v[48:63]
    ds_read_b64_tr_b16 v[212:213], v7 offset:8448
    ds_read_b64_tr_b16 v[214:215], v7 offset:10496
    v_exp_f32 v251, v99
    v_exp_f32 v248, v100
    v_mfma_f32_32x32x16_bf16 v[64:79], v[188:191], v[112:115], v[64:79]
    ds_read_b64_tr_b16 v[228:229], v7 offset:12544
    ds_read_b64_tr_b16 v[230:231], v7 offset:14592
    v_cvt_pk_bf16_f32 v121, v250, v251
    v_exp_f32 v249, v101
    v_mfma_f32_16x16x32_bf16 v[240:243], v[244:247], v[112:115], v[240:243]
    v_exp_f32 v250, v102
    v_mfma_f32_32x32x16_bf16 v[16:31], v[192:195], v[116:119], v[16:31]
    ds_read_b64_tr_b16 v[216:217], v7 offset:8704
    ds_read_b64_tr_b16 v[218:219], v7 offset:10752
    v_cvt_pk_bf16_f32 v122, v248, v249
    v_exp_f32 v251, v103
    v_or3_b32 v252, v120, v121, v122
    v_mfma_f32_32x32x16_bf16 v[32:47], v[196:199], v[116:119], v[32:47]
    ds_read_b64_tr_b16 v[232:233], v7 offset:12800
    ds_read_b64_tr_b16 v[234:235], v7 offset:14848
    v_exp_f32 v248, v104
    v_cvt_pk_bf16_f32 v123, v250, v251
    v_mfma_f32_32x32x16_bf16 v[48:63], v[200:203], v[116:119], v[48:63]
    ds_read_b64_tr_b16 v[220:221], v7 offset:8960
    ds_read_b64_tr_b16 v[222:223], v7 offset:11008
    v_exp_f32 v249, v105
    v_exp_f32 v250, v106
    v_mfma_f32_32x32x16_bf16 v[64:79], v[204:207], v[116:119], v[64:79]
    ds_read_b64_tr_b16 v[236:237], v7 offset:13056
    v_cvt_pk_bf16_f32 v124, v248, v249
    ds_read_b64_tr_b16 v[238:239], v7 offset:15104
    v_exp_f32 v251, v107
    v_or3_b32 v252, v252, v123, v124
    v_exp_f32 v248, v108
    v_cvt_pk_bf16_f32 v125, v250, v251
    v_exp_f32 v249, v109
    v_exp_f32 v250, v110
    v_cvt_pk_bf16_f32 v126, v248, v249
    v_exp_f32 v251, v111
    v_or3_b32 v252, v252, v125, v126
    v_cvt_pk_bf16_f32 v127, v250, v251
    v_bitop3_b32 v252, v252, v127, s66 bitop3:0xa8
    v_cmp_ne_u32 vcc, 0, v252
    v_mfma_f32_16x16x32_bf16 v[240:243], v[244:247], v[116:119], v[240:243]
    s_cbranch_vccnz L_tr1b
L_ret1b:
    s_waitcnt lgkmcnt(0)
    v_mfma_f32_16x16x32_bf16 v[240:243], v[244:247], v[120:123], v[240:243]
    v_mfma_f32_16x16x32_bf16 v[240:243], v[244:247], v[124:127], v[240:243]
    s_barrier
    v_mfma_f32_32x32x16_bf16 v[16:31], v[208:211], v[120:123], v[16:31]
    ds_read_b64_tr_b16 v[176:177], v8 offset:0
    ds_read_b64_tr_b16 v[178:179], v8 offset:1024
    ds_read_b64_tr_b16 v[180:181], v8 offset:2048
    ds_read_b64_tr_b16 v[182:183], v8 offset:3072
    v_mfma_f32_32x32x16_bf16 v[16:31], v[224:227], v[124:127], v[16:31]
    ds_read_b64_tr_b16 v[184:185], v8 offset:4096
    ds_read_b64_tr_b16 v[186:187], v8 offset:5120
    ds_read_b64_tr_b16 v[188:189], v8 offset:6144
    ds_read_b64_tr_b16 v[190:191], v8 offset:7168
    v_mfma_f32_32x32x16_bf16 v[32:47], v[212:215], v[120:123], v[32:47]
    ds_read_b64_tr_b16 v[192:193], v8 offset:8192
    v_rcp_f32 v255, v240
    ds_read_b64_tr_b16 v[194:195], v8 offset:9216
    ds_read_b64_tr_b16 v[196:197], v8 offset:10240
    ds_read_b64_tr_b16 v[198:199], v8 offset:11264
    v_mfma_f32_32x32x16_bf16 v[32:47], v[228:231], v[124:127], v[32:47]
    ds_read_b64_tr_b16 v[200:201], v8 offset:12288
    ds_read_b64_tr_b16 v[202:203], v8 offset:13312
    ds_read_b64_tr_b16 v[204:205], v8 offset:14336
    ds_read_b64_tr_b16 v[206:207], v8 offset:15360
    v_mfma_f32_32x32x16_bf16 v[48:63], v[216:219], v[120:123], v[48:63]
    v_mul_f32 v16, v255, v16
    v_mul_f32 v17, v255, v17
    v_mul_f32 v18, v255, v18
    v_mul_f32 v19, v255, v19
    v_cvt_pk_bf16_f32 v144, v16, v17
    v_cvt_pk_bf16_f32 v145, v18, v19
    v_mfma_f32_32x32x16_bf16 v[48:63], v[232:235], v[124:127], v[48:63]
    v_mul_f32 v20, v255, v20
    v_mul_f32 v21, v255, v21
    v_mul_f32 v22, v255, v22
    v_mul_f32 v23, v255, v23
    v_cvt_pk_bf16_f32 v146, v20, v21
    v_cvt_pk_bf16_f32 v147, v22, v23
    v_mfma_f32_32x32x16_bf16 v[64:79], v[220:223], v[120:123], v[64:79]
    ds_write_b128 v10, v[144:147] offset:0
    v_mul_f32 v24, v255, v24
    v_mul_f32 v25, v255, v25
    v_mul_f32 v26, v255, v26
    v_mul_f32 v27, v255, v27
    v_cvt_pk_bf16_f32 v148, v24, v25
    v_mfma_f32_32x32x16_bf16 v[64:79], v[236:239], v[124:127], v[64:79]
    v_cvt_pk_bf16_f32 v149, v26, v27
    v_mul_f32 v28, v255, v28
    v_mul_f32 v29, v255, v29
    v_mul_f32 v30, v255, v30
    v_mul_f32 v31, v255, v31
    v_cvt_pk_bf16_f32 v150, v28, v29
    v_cvt_pk_bf16_f32 v151, v30, v31
    ds_write_b128 v10, v[148:151] offset:1024
    v_mul_f32 v32, v255, v32
    v_mul_f32 v33, v255, v33
    v_mul_f32 v34, v255, v34
    v_mul_f32 v35, v255, v35
    v_cvt_pk_bf16_f32 v152, v32, v33
    v_cvt_pk_bf16_f32 v153, v34, v35
    v_mul_f32 v36, v255, v36
    v_mul_f32 v37, v255, v37
    v_mul_f32 v38, v255, v38
    v_mul_f32 v39, v255, v39
    s_waitcnt lgkmcnt(2)
    v_mfma_f32_32x32x16_bf16 v[128:143], v[176:179], v[144:147], 0
    ds_read_b64_tr_b16 v[208:209], v9 offset:0
    ds_read_b64_tr_b16 v[210:211], v9 offset:1024
    v_cvt_pk_bf16_f32 v154, v36, v37
    v_cvt_pk_bf16_f32 v155, v38, v39
    ds_write_b128 v10, v[152:155] offset:2048
    v_mul_f32 v40, v255, v40
    v_mfma_f32_32x32x16_bf16 v[128:143], v[180:183], v[148:151], v[128:143]
    v_mul_f32 v41, v255, v41
    ds_read_b64_tr_b16 v[212:213], v9 offset:2048
    v_mul_f32 v42, v255, v42
    ds_read_b64_tr_b16 v[214:215], v9 offset:3072
    v_mul_f32 v43, v255, v43
    v_cvt_pk_bf16_f32 v156, v40, v41
    v_cvt_pk_bf16_f32 v157, v42, v43
    v_mul_f32 v44, v255, v44
    v_mul_f32 v45, v255, v45
    v_mul_f32 v46, v255, v46
    v_mul_f32 v47, v255, v47
    v_cvt_pk_bf16_f32 v158, v44, v45
    v_cvt_pk_bf16_f32 v159, v46, v47
    ds_write_b128 v10, v[156:159] offset:3072
    s_nop 0
    v_mfma_f32_32x32x16_bf16 v[128:143], v[184:187], v[152:155], v[128:143]
    ds_read_b64_tr_b16 v[216:217], v9 offset:4096
    ds_read_b64_tr_b16 v[218:219], v9 offset:5120
    ds_read_b64_tr_b16 v[220:221], v9 offset:6144
    ds_read_b64_tr_b16 v[222:223], v9 offset:7168
    v_mul_f32 v48, v255, v48
    v_mul_f32 v49, v255, v49
    v_mfma_f32_32x32x16_bf16 v[128:143], v[188:191], v[156:159], v[128:143]
    ds_read_b64_tr_b16 v[224:225], v9 offset:8192
    ds_read_b64_tr_b16 v[226:227], v9 offset:9216
    ds_read_b64_tr_b16 v[228:229], v9 offset:10240
    ds_read_b64_tr_b16 v[230:231], v9 offset:11264
    v_mul_f32 v50, v255, v50
    v_mul_f32 v51, v255, v51
    v_cvt_pk_bf16_f32 v160, v48, v49
    v_cvt_pk_bf16_f32 v161, v50, v51
    v_mul_f32 v52, v255, v52
    v_mul_f32 v53, v255, v53
    v_mul_f32 v54, v255, v54
    v_mul_f32 v55, v255, v55
    v_cvt_pk_bf16_f32 v162, v52, v53
    v_cvt_pk_bf16_f32 v163, v54, v55
    ds_write_b128 v10, v[160:163] offset:4096
    v_mul_f32 v56, v255, v56
    v_mul_f32 v57, v255, v57
    v_mul_f32 v58, v255, v58
    v_mul_f32 v59, v255, v59
    v_cvt_pk_bf16_f32 v164, v56, v57
    v_cvt_pk_bf16_f32 v165, v58, v59
    v_mul_f32 v60, v255, v60
    v_mul_f32 v61, v255, v61
    v_mul_f32 v62, v255, v62
    v_mul_f32 v63, v255, v63
    v_cvt_pk_bf16_f32 v166, v60, v61
    v_cvt_pk_bf16_f32 v167, v62, v63
    ds_write_b128 v10, v[164:167] offset:5120
    v_mul_f32 v64, v255, v64
    v_mul_f32 v65, v255, v65
    v_mul_f32 v66, v255, v66
    v_mul_f32 v67, v255, v67
    v_cvt_pk_bf16_f32 v168, v64, v65
    v_cvt_pk_bf16_f32 v169, v66, v67
    v_mul_f32 v68, v255, v68
    v_mul_f32 v69, v255, v69
    v_mul_f32 v70, v255, v70
    v_mul_f32 v71, v255, v71
    v_cvt_pk_bf16_f32 v170, v68, v69
    v_cvt_pk_bf16_f32 v171, v70, v71
    ds_write_b128 v10, v[168:171] offset:6144
    v_mul_f32 v72, v255, v72
    v_mul_f32 v73, v255, v73
    v_mul_f32 v74, v255, v74
    v_mul_f32 v75, v255, v75
    v_cvt_pk_bf16_f32 v172, v72, v73
    v_cvt_pk_bf16_f32 v173, v74, v75
    v_mul_f32 v76, v255, v76
    v_mul_f32 v77, v255, v77
    v_mul_f32 v78, v255, v78
    v_mul_f32 v79, v255, v79
    v_cvt_pk_bf16_f32 v174, v76, v77
    v_cvt_pk_bf16_f32 v175, v78, v79
    ds_write_b128 v10, v[172:175] offset:7168
    ds_read_b64_tr_b16 v[232:233], v9 offset:12288
    ds_read_b64_tr_b16 v[234:235], v9 offset:13312
    ds_read_b64_tr_b16 v[236:237], v9 offset:14336
    ds_read_b64_tr_b16 v[238:239], v9 offset:15360
    s_waitcnt lgkmcnt(0)
    s_barrier
    ds_read_b128 v[80:83], v11 offset:0
    ds_read_b128 v[84:87], v11 offset:1024
    v_mfma_f32_32x32x16_bf16 v[128:143], v[192:195], v[160:163], v[128:143]
    ds_read_b128 v[88:91], v11 offset:2048
    ds_read_b128 v[92:95], v11 offset:3072
    ds_read_b128 v[96:99], v11 offset:4096
    v_mfma_f32_32x32x16_bf16 v[128:143], v[196:199], v[164:167], v[128:143]
    ds_read_b128 v[100:103], v11 offset:5120
    ds_read_b128 v[104:107], v11 offset:6144
    ds_read_b128 v[108:111], v11 offset:7168
    v_mfma_f32_32x32x16_bf16 v[128:143], v[200:203], v[168:171], v[128:143]
    v_add_u32 v8, 131072, v8
    v_add_u32 v9, 131072, v9
    s_mov_b32 s63, 4294901760
    s_mov_b32 s62, 0
    s_mov_b32 s56, 250753007
    v_mov_b32 v2, 0
    v_mfma_f32_32x32x16_bf16 v[128:143], v[204:207], v[172:175], v[128:143]
    v_mov_b32 v3, 0
    v_mov_b32 v4, 1
    v_mov_b32 v13, -2
    s_waitcnt lgkmcnt(0)
    s_branch L_o1
L_o:
    s_barrier
    buffer_store_dwordx4 v[240:243], v1, s[44:47], s69 offen sc1
    buffer_store_dwordx4 v[244:247], v1, s[44:47], s70 offen sc1
L_o1:
    v_mfma_f32_32x32x16_bf16 v[128:143], v[208:211], v[80:83], v[128:143]
    ds_read_b64_tr_b16 v[176:177], v8 offset:0
    ds_read_b64_tr_b16 v[178:179], v8 offset:1024
    s_bfe_i32 s63, s56, 0x40000
    s_lshl_b32 s63, s63, 15
    s_lshr_b32 s56, s56, 4
    s_waitcnt lgkmcnt(14)
    v_mfma_f32_32x32x16_bf16 v[128:143], v[212:215], v[84:87], v[128:143]
    ds_read_b64_tr_b16 v[180:181], v8 offset:2048
    ds_read_b64_tr_b16 v[182:183], v8 offset:3072
    s_add_u32 s69, s69, 131072
    s_cmp_eq_u32 s69, s71
    s_cselect_b32 s60, 1179648, 0
    s_waitcnt lgkmcnt(14)
    v_mfma_f32_32x32x16_bf16 v[128:143], v[216:219], v[88:91], v[128:143]
    ds_read_b64_tr_b16 v[184:185], v8 offset:4096
    ds_read_b64_tr_b16 v[186:187], v8 offset:5120
    s_sub_u32 s69, s69, s60
    s_add_u32 s70, s69, 16384
    s_waitcnt lgkmcnt(14)
    v_mfma_f32_32x32x16_bf16 v[128:143], v[220:223], v[92:95], v[128:143]
    ds_read_b64_tr_b16 v[188:189], v8 offset:6144
    ds_read_b64_tr_b16 v[190:191], v8 offset:7168
    s_waitcnt lgkmcnt(14)
    v_mfma_f32_32x32x16_bf16 v[128:143], v[224:227], v[96:99], v[128:143]
    ds_read_b64_tr_b16 v[192:193], v8 offset:8192
    ds_read_b64_tr_b16 v[194:195], v8 offset:9216
    s_waitcnt lgkmcnt(14)
    v_mfma_f32_32x32x16_bf16 v[128:143], v[228:231], v[100:103], v[128:143]
    ds_read_b64_tr_b16 v[196:197], v8 offset:10240
    ds_read_b64_tr_b16 v[198:199], v8 offset:11264
    s_waitcnt lgkmcnt(14)
    v_mfma_f32_32x32x16_bf16 v[128:143], v[232:235], v[104:107], v[128:143]
    ds_read_b64_tr_b16 v[200:201], v8 offset:12288
    ds_read_b64_tr_b16 v[202:203], v8 offset:13312
    s_waitcnt lgkmcnt(14)
    v_mfma_f32_32x32x16_bf16 v[128:143], v[236:239], v[108:111], v[128:143]
    ds_read_b64_tr_b16 v[204:205], v8 offset:14336
    ds_read_b64_tr_b16 v[206:207], v8 offset:15360
    s_waitcnt lgkmcnt(14)
    v_mfma_f32_32x32x16_bf16 v[112:127], v[176:179], v[144:147], 0
    ds_read_b64_tr_b16 v[208:209], v9 offset:0
    ds_read_b64_tr_b16 v[210:211], v9 offset:1024
    v_add_u32 v8, s63, v8
    s_waitcnt lgkmcnt(14)
    v_mfma_f32_32x32x16_bf16 v[112:127], v[180:183], v[148:151], v[112:127]
    ds_read_b64_tr_b16 v[212:213], v9 offset:2048
    ds_read_b64_tr_b16 v[214:215], v9 offset:3072
    s_waitcnt lgkmcnt(14)
    v_mfma_f32_32x32x16_bf16 v[112:127], v[184:187], v[152:155], v[112:127]
    ds_read_b64_tr_b16 v[216:217], v9 offset:4096
    ds_read_b64_tr_b16 v[218:219], v9 offset:5120
    s_waitcnt lgkmcnt(14)
    v_mfma_f32_32x32x16_bf16 v[112:127], v[188:191], v[156:159], v[112:127]
    ds_read_b64_tr_b16 v[220:221], v9 offset:6144
    ds_read_b64_tr_b16 v[222:223], v9 offset:7168
    v_cvt_pk_bf16_f32 v240, v128, v129
    v_cvt_pk_bf16_f32 v241, v130, v131
    v_cvt_pk_bf16_f32 v242, v132, v133
    s_waitcnt lgkmcnt(14)
    v_mfma_f32_32x32x16_bf16 v[112:127], v[192:195], v[160:163], v[112:127]
    ds_read_b64_tr_b16 v[224:225], v9 offset:8192
    ds_read_b64_tr_b16 v[226:227], v9 offset:9216
    v_cvt_pk_bf16_f32 v243, v134, v135
    v_cvt_pk_bf16_f32 v244, v136, v137
    v_cvt_pk_bf16_f32 v245, v138, v139
    s_waitcnt lgkmcnt(14)
    v_mfma_f32_32x32x16_bf16 v[112:127], v[196:199], v[164:167], v[112:127]
    ds_read_b64_tr_b16 v[228:229], v9 offset:10240
    ds_read_b64_tr_b16 v[230:231], v9 offset:11264
    v_cvt_pk_bf16_f32 v246, v140, v141
    v_cvt_pk_bf16_f32 v247, v142, v143
    s_waitcnt lgkmcnt(14)
    v_mfma_f32_32x32x16_bf16 v[112:127], v[200:203], v[168:171], v[112:127]
    ds_read_b64_tr_b16 v[232:233], v9 offset:12288
    ds_read_b64_tr_b16 v[234:235], v9 offset:13312
    s_waitcnt lgkmcnt(14)
    v_mfma_f32_32x32x16_bf16 v[112:127], v[204:207], v[172:175], v[112:127]
    ds_read_b64_tr_b16 v[236:237], v9 offset:14336
    ds_read_b64_tr_b16 v[238:239], v9 offset:15360
    v_add_u32 v9, s63, v9
    s_waitcnt lgkmcnt(14)
    s_cmp_eq_u32 s62, 3
    s_cbranch_scc1 L_nob2
    s_barrier
L_nob2:
    buffer_store_dwordx4 v[240:243], v1, s[44:47], s69 offen sc1
    buffer_store_dwordx4 v[244:247], v1, s[44:47], s70 offen sc1
    v_mfma_f32_32x32x16_bf16 v[112:127], v[208:211], v[80:83], v[112:127]
    ds_read_b64_tr_b16 v[176:177], v8 offset:0
    ds_read_b64_tr_b16 v[178:179], v8 offset:1024
    s_bfe_i32 s63, s56, 0x40000
    s_lshl_b32 s63, s63, 15
    s_lshr_b32 s56, s56, 4
    s_waitcnt lgkmcnt(14)
    v_mfma_f32_32x32x16_bf16 v[112:127], v[212:215], v[84:87], v[112:127]
    ds_read_b64_tr_b16 v[180:181], v8 offset:2048
    ds_read_b64_tr_b16 v[182:183], v8 offset:3072
    s_add_u32 s69, s69, 131072
    s_cmp_eq_u32 s69, s71
    s_cselect_b32 s60, 1179648, 0
    s_waitcnt lgkmcnt(14)
    v_mfma_f32_32x32x16_bf16 v[112:127], v[216:219], v[88:91], v[112:127]
    ds_read_b64_tr_b16 v[184:185], v8 offset:4096
    ds_read_b64_tr_b16 v[186:187], v8 offset:5120
    s_sub_u32 s69, s69, s60
    s_add_u32 s70, s69, 16384
    s_waitcnt lgkmcnt(14)
    v_mfma_f32_32x32x16_bf16 v[112:127], v[220:223], v[92:95], v[112:127]
    ds_read_b64_tr_b16 v[188:189], v8 offset:6144
    ds_read_b64_tr_b16 v[190:191], v8 offset:7168
    s_waitcnt lgkmcnt(14)
    v_mfma_f32_32x32x16_bf16 v[112:127], v[224:227], v[96:99], v[112:127]
    ds_read_b64_tr_b16 v[192:193], v8 offset:8192
    ds_read_b64_tr_b16 v[194:195], v8 offset:9216
    s_waitcnt lgkmcnt(14)
    v_mfma_f32_32x32x16_bf16 v[112:127], v[228:231], v[100:103], v[112:127]
    ds_read_b64_tr_b16 v[196:197], v8 offset:10240
    ds_read_b64_tr_b16 v[198:199], v8 offset:11264
    s_waitcnt lgkmcnt(14)
    v_mfma_f32_32x32x16_bf16 v[112:127], v[232:235], v[104:107], v[112:127]
    ds_read_b64_tr_b16 v[200:201], v8 offset:12288
    ds_read_b64_tr_b16 v[202:203], v8 offset:13312
    s_waitcnt lgkmcnt(14)
    v_mfma_f32_32x32x16_bf16 v[112:127], v[236:239], v[108:111], v[112:127]
    ds_read_b64_tr_b16 v[204:205], v8 offset:14336
    ds_read_b64_tr_b16 v[206:207], v8 offset:15360
    s_waitcnt lgkmcnt(14)
    v_mfma_f32_32x32x16_bf16 v[128:143], v[176:179], v[144:147], 0
    ds_read_b64_tr_b16 v[208:209], v9 offset:0
    ds_read_b64_tr_b16 v[210:211], v9 offset:1024
    v_add_u32 v8, s63, v8
    s_waitcnt lgkmcnt(14)
    v_mfma_f32_32x32x16_bf16 v[128:143], v[180:183], v[148:151], v[128:143]
    ds_read_b64_tr_b16 v[212:213], v9 offset:2048
    ds_read_b64_tr_b16 v[214:215], v9 offset:3072
    s_waitcnt lgkmcnt(14)
    v_mfma_f32_32x32x16_bf16 v[128:143], v[184:187], v[152:155], v[128:143]
    ds_read_b64_tr_b16 v[216:217], v9 offset:4096
    ds_read_b64_tr_b16 v[218:219], v9 offset:5120
    s_waitcnt lgkmcnt(14)
    v_mfma_f32_32x32x16_bf16 v[128:143], v[188:191], v[156:159], v[128:143]
    ds_read_b64_tr_b16 v[220:221], v9 offset:6144
    ds_read_b64_tr_b16 v[222:223], v9 offset:7168
    v_cvt_pk_bf16_f32 v240, v112, v113
    v_cvt_pk_bf16_f32 v241, v114, v115
    v_cvt_pk_bf16_f32 v242, v116, v117
    s_waitcnt lgkmcnt(14)
    v_mfma_f32_32x32x16_bf16 v[128:143], v[192:195], v[160:163], v[128:143]
    ds_read_b64_tr_b16 v[224:225], v9 offset:8192
    ds_read_b64_tr_b16 v[226:227], v9 offset:9216
    v_cvt_pk_bf16_f32 v243, v118, v119
    v_cvt_pk_bf16_f32 v244, v120, v121
    v_cvt_pk_bf16_f32 v245, v122, v123
    s_waitcnt lgkmcnt(14)
    v_mfma_f32_32x32x16_bf16 v[128:143], v[196:199], v[164:167], v[128:143]
    ds_read_b64_tr_b16 v[228:229], v9 offset:10240
    ds_read_b64_tr_b16 v[230:231], v9 offset:11264
    v_cvt_pk_bf16_f32 v246, v124, v125
    v_cvt_pk_bf16_f32 v247, v126, v127
    s_add_u32 s62, s62, 1
    s_waitcnt lgkmcnt(14)
    v_mfma_f32_32x32x16_bf16 v[128:143], v[200:203], v[168:171], v[128:143]
    ds_read_b64_tr_b16 v[232:233], v9 offset:12288
    ds_read_b64_tr_b16 v[234:235], v9 offset:13312
    s_waitcnt lgkmcnt(14)
    v_mfma_f32_32x32x16_bf16 v[128:143], v[204:207], v[172:175], v[128:143]
    ds_read_b64_tr_b16 v[236:237], v9 offset:14336
    ds_read_b64_tr_b16 v[238:239], v9 offset:15360
    s_cmp_lt_u32 s62, 4
    v_add_u32 v9, s63, v9
    s_waitcnt lgkmcnt(14)
    s_cbranch_scc1 L_o
    buffer_store_dwordx4 v[240:243], v1, s[44:47], s69 offen sc1
    buffer_store_dwordx4 v[244:247], v1, s[44:47], s70 offen sc1
    s_add_u32 s69, s69, 131072
    s_cmp_eq_u32 s69, s71
    s_cselect_b32 s60, 1179648, 0
    s_sub_u32 s69, s69, s60
    s_add_u32 s70, s69, 16384
    v_mfma_f32_32x32x16_bf16 v[128:143], v[208:211], v[80:83], v[128:143]
    s_waitcnt lgkmcnt(12)
    v_mfma_f32_32x32x16_bf16 v[128:143], v[212:215], v[84:87], v[128:143]
    s_waitcnt lgkmcnt(10)
    v_mfma_f32_32x32x16_bf16 v[128:143], v[216:219], v[88:91], v[128:143]
    s_waitcnt lgkmcnt(8)
    v_mfma_f32_32x32x16_bf16 v[128:143], v[220:223], v[92:95], v[128:143]
    s_waitcnt lgkmcnt(6)
    v_mfma_f32_32x32x16_bf16 v[128:143], v[224:227], v[96:99], v[128:143]
    s_waitcnt lgkmcnt(4)
    v_mfma_f32_32x32x16_bf16 v[128:143], v[228:231], v[100:103], v[128:143]
    s_waitcnt lgkmcnt(2)
    v_mfma_f32_32x32x16_bf16 v[128:143], v[232:235], v[104:107], v[128:143]
    s_waitcnt lgkmcnt(0)
    v_mfma_f32_32x32x16_bf16 v[128:143], v[236:239], v[108:111], v[128:143]
    s_nop 11
    v_cvt_pk_bf16_f32 v240, v128, v129
    v_cvt_pk_bf16_f32 v241, v130, v131
    v_cvt_pk_bf16_f32 v242, v132, v133
    v_cvt_pk_bf16_f32 v243, v134, v135
    buffer_store_dwordx4 v[240:243], v1, s[44:47], s69 offen sc1
    v_cvt_pk_bf16_f32 v244, v136, v137
    v_cvt_pk_bf16_f32 v245, v138, v139
    v_cvt_pk_bf16_f32 v246, v140, v141
    v_cvt_pk_bf16_f32 v247, v142, v143
    buffer_store_dwordx4 v[244:247], v1, s[44:47], s70 offen sc1
L_arr:
    s_lshl3_add_u32 s56, s6, s8
    s_lshl_b32 s56, s56, 4
    s_mov_b32 s58, 1
    s_waitcnt vmcnt(0)
    buffer_store_dword v4, v12, s[44:47], 0 offen offset:0 sc1
    s_mov_b64 exec, 1
    ds_add_rtn_u32 v2, v3, v4 offset:4
    s_waitcnt lgkmcnt(0)
    v_readfirstlane_b32 s60, v2
    s_cmp_lg_u32 s60, 3
    s_cbranch_scc1 L_fin
    s_mov_b64 exec, -1
    s_atomic_add s58, s[96:97], s56 glc
    s_waitcnt lgkmcnt(0)
    s_and_b32 s60, s58, 0xff
    s_cmp_lg_u32 s60, 15
    s_cbranch_scc1 L_fin
    s_lshr_b32 s58, s58, 16
    s_cbranch_scc0 L_fin
    v_and_b32 v1, 63, v0
    v_and_b32 v2, 7, v1
    v_lshlrev_b32 v4, 4, v2
    v_bfe_u32 v3, v1, 3, 1
    v_lshl_add_u32 v4, v3, 14, v4
    v_lshlrev_b32 v5, 5, v3
    v_bfe_u32 v6, v1, 1, 3
    v_bfe_u32 v3, v1, 4, 1
    v_lshl_add_u32 v4, v3, 16, v4
    v_lshl_add_u32 v5, v3, 3, v5
    v_lshlrev_b32 v3, 2, v3
    v_xor_b32 v6, v6, v3
    v_lshrrev_b32 v3, 5, v1
    v_lshl_add_u32 v4, v3, 13, v4
    v_lshl_add_u32 v5, v3, 6, v5
    v_bfe_u32 v3, v1, 2, 1
    v_lshl_add_u32 v5, v3, 4, v5
    v_and_b32 v3, 3, v1
    v_mul_u32_u24 v3, 2304, v3
    v_add_u32 v5, v5, v3
    v_and_b32 v3, 1, v1
    v_lshlrev_b32 v3, 4, v3
    v_mov_b32 v7, 0x3f80
    v_lshlrev_b32 v3, v3, v7
    v_cmp_eq_u32 s[12:13], 0, v6
    v_cmp_eq_u32 s[14:15], 1, v6
    v_cmp_eq_u32 s[16:17], 2, v6
    v_cmp_eq_u32 s[18:19], 3, v6
    v_cndmask_b32 v8, 0, v3, s[12:13]
    v_cndmask_b32 v9, 0, v3, s[14:15]
    v_cndmask_b32 v10, 0, v3, s[16:17]
    v_cndmask_b32 v11, 0, v3, s[18:19]
    v_and_b32 v1, 31, v1
    v_lshlrev_b32 v1, 2, v1
    s_lshl3_add_u32 s56, s6, s8
    s_mul_i32 s68, s56, 1179648
    s_mul_i32 s22, s56, 2304
    s_add_u32 s22, s22, 18874368
    s_lshl_b32 s56, s56, 4
    s_lshr_b32 s60, s7, 1
    s_lshl_b32 s60, s60, 8
    s_add_u32 s22, s22, s60
    s_mul_i32 s69, s8, 147456
    s_mul_i32 s60, s6, 1152
    s_add_u32 s69, s69, s60
    s_mov_b32 s71, 1
    s_mov_b32 s11, 0
    s_branch L_piece
L_tr1a:
    s_mov_b32 s11, 0
    s_branch L_rare1
L_tr1b:
    s_mov_b32 s11, 1
    s_branch L_rare1
L_tr0a:
    s_mov_b32 s11, 0
    s_branch L_rare0
L_tr0b:
    s_mov_b32 s11, 1
    s_branch L_rare0
L_rare1:
    s_nop 15
    v_max3_f32 v253, v96, v97, v98
    v_max3_f32 v254, v99, v100, v101
    v_max3_f32 v253, v253, v102, v103
    v_max3_f32 v254, v254, v104, v105
    v_max3_f32 v253, v253, v106, v107
    v_max3_f32 v254, v254, v108, v109
    v_max3_f32 v253, v253, v110, v111
    v_max_f32 v253, v253, v254
    v_mov_b32 v254, v253
    s_nop 1
    v_permlane32_swap_b32 v254, v253
    s_nop 0
    v_max_f32 v253, v253, v254
    v_add_f32 v253, 0x41700000, v253
    v_max_f32 v253, 0, v253
    v_ceil_f32 v253, v253
    v_cvt_i32_f32 v254, v253
    v_sub_u32 v254, 0, v254
    v_ldexp_f32 v16, v16, v254
    v_ldexp_f32 v17, v17, v254
    v_ldexp_f32 v18, v18, v254
    v_ldexp_f32 v19, v19, v254
    v_ldexp_f32 v20, v20, v254
    v_ldexp_f32 v21, v21, v254
    v_ldexp_f32 v22, v22, v254
    v_ldexp_f32 v23, v23, v254
    v_ldexp_f32 v24, v24, v254
    v_ldexp_f32 v25, v25, v254
    v_ldexp_f32 v26, v26, v254
    v_ldexp_f32 v27, v27, v254
    v_ldexp_f32 v28, v28, v254
    v_ldexp_f32 v29, v29, v254
    v_ldexp_f32 v30, v30, v254
    v_ldexp_f32 v31, v31, v254
    v_ldexp_f32 v32, v32, v254
    v_ldexp_f32 v33, v33, v254
    v_ldexp_f32 v34, v34, v254
    v_ldexp_f32 v35, v35, v254
    v_ldexp_f32 v36, v36, v254
    v_ldexp_f32 v37, v37, v254
    v_ldexp_f32 v38, v38, v254
    v_ldexp_f32 v39, v39, v254
    v_ldexp_f32 v40, v40, v254
    v_ldexp_f32 v41, v41, v254
    v_ldexp_f32 v42, v42, v254
    v_ldexp_f32 v43, v43, v254
    v_ldexp_f32 v44, v44, v254
    v_ldexp_f32 v45, v45, v254
    v_ldexp_f32 v46, v46, v254
    v_ldexp_f32 v47, v47, v254
    v_ldexp_f32 v48, v48, v254
    v_ldexp_f32 v49, v49, v254
    v_ldexp_f32 v50, v50, v254
    v_ldexp_f32 v51, v51, v254
    v_ldexp_f32 v52, v52, v254
    v_ldexp_f32 v53, v53, v254
    v_ldexp_f32 v54, v54, v254
    v_ldexp_f32 v55, v55, v254
    v_ldexp_f32 v56, v56, v254
    v_ldexp_f32 v57, v57, v254
    v_ldexp_f32 v58, v58, v254
    v_ldexp_f32 v59, v59, v254
    v_ldexp_f32 v60, v60, v254
    v_ldexp_f32 v61, v61, v254
    v_ldexp_f32 v62, v62, v254
    v_ldexp_f32 v63, v63, v254
    v_ldexp_f32 v64, v64, v254
    v_ldexp_f32 v65, v65, v254
    v_ldexp_f32 v66, v66, v254
    v_ldexp_f32 v67, v67, v254
    v_ldexp_f32 v68, v68, v254
    v_ldexp_f32 v69, v69, v254
    v_ldexp_f32 v70, v70, v254
    v_ldexp_f32 v71, v71, v254
    v_ldexp_f32 v72, v72, v254
    v_ldexp_f32 v73, v73, v254
    v_ldexp_f32 v74, v74, v254
    v_ldexp_f32 v75, v75, v254
    v_ldexp_f32 v76, v76, v254
    v_ldexp_f32 v77, v77, v254
    v_ldexp_f32 v78, v78, v254
    v_ldexp_f32 v79, v79, v254
    v_ldexp_f32 v240, v240, v254
    v_sub_f32 v96, v96, v253
    v_sub_f32 v97, v97, v253
    v_sub_f32 v98, v98, v253
    v_sub_f32 v99, v99, v253
    v_sub_f32 v100, v100, v253
    v_sub_f32 v101, v101, v253
    v_sub_f32 v102, v102, v253
    v_sub_f32 v103, v103, v253
    v_sub_f32 v104, v104, v253
    v_sub_f32 v105, v105, v253
    v_sub_f32 v106, v106, v253
    v_sub_f32 v107, v107, v253
    v_sub_f32 v108, v108, v253
    v_sub_f32 v109, v109, v253
    v_sub_f32 v110, v110, v253
    v_sub_f32 v111, v111, v253
    v_sub_f32 v80, v80, v253
    v_sub_f32 v81, v81, v253
    v_sub_f32 v82, v82, v253
    v_sub_f32 v83, v83, v253
    v_sub_f32 v84, v84, v253
    v_sub_f32 v85, v85, v253
    v_sub_f32 v86, v86, v253
    v_sub_f32 v87, v87, v253
    v_sub_f32 v88, v88, v253
    v_sub_f32 v89, v89, v253
    v_sub_f32 v90, v90, v253
    v_sub_f32 v91, v91, v253
    v_sub_f32 v92, v92, v253
    v_sub_f32 v93, v93, v253
    v_sub_f32 v94, v94, v253
    v_sub_f32 v95, v95, v253
    v_sub_f32 v128, v128, v253
    v_sub_f32 v129, v129, v253
    v_sub_f32 v130, v130, v253
    v_sub_f32 v131, v131, v253
    v_sub_f32 v132, v132, v253
    v_sub_f32 v133, v133, v253
    v_sub_f32 v134, v134, v253
    v_sub_f32 v135, v135, v253
    v_sub_f32 v136, v136, v253
    v_sub_f32 v137, v137, v253
    v_sub_f32 v138, v138, v253
    v_sub_f32 v139, v139, v253
    v_sub_f32 v140, v140, v253
    v_sub_f32 v141, v141, v253
    v_sub_f32 v142, v142, v253
    v_sub_f32 v143, v143, v253
    v_exp_f32 v248, v96
    v_exp_f32 v249, v97
    v_exp_f32 v250, v98
    v_cvt_pk_bf16_f32 v120, v248, v249
    v_exp_f32 v251, v99
    v_exp_f32 v248, v100
    v_cvt_pk_bf16_f32 v121, v250, v251
    v_exp_f32 v249, v101
    v_exp_f32 v250, v102
    v_cvt_pk_bf16_f32 v122, v248, v249
    v_exp_f32 v251, v103
    v_or3_b32 v252, v120, v121, v122
    v_exp_f32 v248, v104
    v_cvt_pk_bf16_f32 v123, v250, v251
    v_exp_f32 v249, v105
    v_exp_f32 v250, v106
    v_cvt_pk_bf16_f32 v124, v248, v249
    v_exp_f32 v251, v107
    v_or3_b32 v252, v252, v123, v124
    v_exp_f32 v248, v108
    v_cvt_pk_bf16_f32 v125, v250, v251
    v_exp_f32 v249, v109
    v_exp_f32 v250, v110
    v_cvt_pk_bf16_f32 v126, v248, v249
    v_exp_f32 v251, v111
    v_or3_b32 v252, v252, v125, v126
    v_cvt_pk_bf16_f32 v127, v250, v251
    s_nop 1
    s_cmp_eq_u32 s11, 0
    s_cbranch_scc1 L_ret1a
    s_branch L_ret1b
L_rare0:
    s_nop 15
    v_max3_f32 v253, v80, v81, v82
    v_max3_f32 v254, v83, v84, v85
    v_max3_f32 v253, v253, v86, v87
    v_max3_f32 v254, v254, v88, v89
    v_max3_f32 v253, v253, v90, v91
    v_max3_f32 v254, v254, v92, v93
    v_max3_f32 v253, v253, v94, v95
    v_max_f32 v253, v253, v254
    v_mov_b32 v254, v253
    s_nop 1
    v_permlane32_swap_b32 v254, v253
    s_nop 0
    v_max_f32 v253, v253, v254
    v_add_f32 v253, 0x41700000, v253
    v_max_f32 v253, 0, v253
    v_ceil_f32 v253, v253
    v_cvt_i32_f32 v254, v253
    v_sub_u32 v254, 0, v254
    v_ldexp_f32 v16, v16, v254
    v_ldexp_f32 v17, v17, v254
    v_ldexp_f32 v18, v18, v254
    v_ldexp_f32 v19, v19, v254
    v_ldexp_f32 v20, v20, v254
    v_ldexp_f32 v21, v21, v254
    v_ldexp_f32 v22, v22, v254
    v_ldexp_f32 v23, v23, v254
    v_ldexp_f32 v24, v24, v254
    v_ldexp_f32 v25, v25, v254
    v_ldexp_f32 v26, v26, v254
    v_ldexp_f32 v27, v27, v254
    v_ldexp_f32 v28, v28, v254
    v_ldexp_f32 v29, v29, v254
    v_ldexp_f32 v30, v30, v254
    v_ldexp_f32 v31, v31, v254
    v_ldexp_f32 v32, v32, v254
    v_ldexp_f32 v33, v33, v254
    v_ldexp_f32 v34, v34, v254
    v_ldexp_f32 v35, v35, v254
    v_ldexp_f32 v36, v36, v254
    v_ldexp_f32 v37, v37, v254
    v_ldexp_f32 v38, v38, v254
    v_ldexp_f32 v39, v39, v254
    v_ldexp_f32 v40, v40, v254
    v_ldexp_f32 v41, v41, v254
    v_ldexp_f32 v42, v42, v254
    v_ldexp_f32 v43, v43, v254
    v_ldexp_f32 v44, v44, v254
    v_ldexp_f32 v45, v45, v254
    v_ldexp_f32 v46, v46, v254
    v_ldexp_f32 v47, v47, v254
    v_ldexp_f32 v48, v48, v254
    v_ldexp_f32 v49, v49, v254
    v_ldexp_f32 v50, v50, v254
    v_ldexp_f32 v51, v51, v254
    v_ldexp_f32 v52, v52, v254
    v_ldexp_f32 v53, v53, v254
    v_ldexp_f32 v54, v54, v254
    v_ldexp_f32 v55, v55, v254
    v_ldexp_f32 v56, v56, v254
    v_ldexp_f32 v57, v57, v254
    v_ldexp_f32 v58, v58, v254
    v_ldexp_f32 v59, v59, v254
    v_ldexp_f32 v60, v60, v254
    v_ldexp_f32 v61, v61, v254
    v_ldexp_f32 v62, v62, v254
    v_ldexp_f32 v63, v63, v254
    v_ldexp_f32 v64, v64, v254
    v_ldexp_f32 v65, v65, v254
    v_ldexp_f32 v66, v66, v254
    v_ldexp_f32 v67, v67, v254
    v_ldexp_f32 v68, v68, v254
    v_ldexp_f32 v69, v69, v254
    v_ldexp_f32 v70, v70, v254
    v_ldexp_f32 v71, v71, v254
    v_ldexp_f32 v72, v72, v254
    v_ldexp_f32 v73, v73, v254
    v_ldexp_f32 v74, v74, v254
    v_ldexp_f32 v75, v75, v254
    v_ldexp_f32 v76, v76, v254
    v_ldexp_f32 v77, v77, v254
    v_ldexp_f32 v78, v78, v254
    v_ldexp_f32 v79, v79, v254
    v_ldexp_f32 v240, v240, v254
    v_sub_f32 v80, v80, v253
    v_sub_f32 v81, v81, v253
    v_sub_f32 v82, v82, v253
    v_sub_f32 v83, v83, v253
    v_sub_f32 v84, v84, v253
    v_sub_f32 v85, v85, v253
    v_sub_f32 v86, v86, v253
    v_sub_f32 v87, v87, v253
    v_sub_f32 v88, v88, v253
    v_sub_f32 v89, v89, v253
    v_sub_f32 v90, v90, v253
    v_sub_f32 v91, v91, v253
    v_sub_f32 v92, v92, v253
    v_sub_f32 v93, v93, v253
    v_sub_f32 v94, v94, v253
    v_sub_f32 v95, v95, v253
    v_sub_f32 v96, v96, v253
    v_sub_f32 v97, v97, v253
    v_sub_f32 v98, v98, v253
    v_sub_f32 v99, v99, v253
    v_sub_f32 v100, v100, v253
    v_sub_f32 v101, v101, v253
    v_sub_f32 v102, v102, v253
    v_sub_f32 v103, v103, v253
    v_sub_f32 v104, v104, v253
    v_sub_f32 v105, v105, v253
    v_sub_f32 v106, v106, v253
    v_sub_f32 v107, v107, v253
    v_sub_f32 v108, v108, v253
    v_sub_f32 v109, v109, v253
    v_sub_f32 v110, v110, v253
    v_sub_f32 v111, v111, v253
    v_sub_f32 v128, v128, v253
    v_sub_f32 v129, v129, v253
    v_sub_f32 v130, v130, v253
    v_sub_f32 v131, v131, v253
    v_sub_f32 v132, v132, v253
    v_sub_f32 v133, v133, v253
    v_sub_f32 v134, v134, v253
    v_sub_f32 v135, v135, v253
    v_sub_f32 v136, v136, v253
    v_sub_f32 v137, v137, v253
    v_sub_f32 v138, v138, v253
    v_sub_f32 v139, v139, v253
    v_sub_f32 v140, v140, v253
    v_sub_f32 v141, v141, v253
    v_sub_f32 v142, v142, v253
    v_sub_f32 v143, v143, v253
    v_exp_f32 v248, v80
    v_exp_f32 v249, v81
    v_exp_f32 v250, v82
    v_cvt_pk_bf16_f32 v112, v248, v249
    v_exp_f32 v251, v83
    v_exp_f32 v248, v84
    v_cvt_pk_bf16_f32 v113, v250, v251
    v_exp_f32 v249, v85
    v_exp_f32 v250, v86
    v_cvt_pk_bf16_f32 v114, v248, v249
    v_exp_f32 v251, v87
    v_or3_b32 v252, v112, v113, v114
    v_exp_f32 v248, v88
    v_cvt_pk_bf16_f32 v115, v250, v251
    v_exp_f32 v249, v89
    v_exp_f32 v250, v90
    v_cvt_pk_bf16_f32 v116, v248, v249
    v_exp_f32 v251, v91
    v_or3_b32 v252, v252, v115, v116
    v_exp_f32 v248, v92
    v_cvt_pk_bf16_f32 v117, v250, v251
    v_exp_f32 v249, v93
    v_exp_f32 v250, v94
    v_cvt_pk_bf16_f32 v118, v248, v249
    v_exp_f32 v251, v95
    v_or3_b32 v252, v252, v117, v118
    v_cvt_pk_bf16_f32 v119, v250, v251
    s_nop 1
    s_cmp_eq_u32 s11, 0
    s_cbranch_scc1 L_ret0a
    s_branch L_ret0b
.section .rodata,"a"
.p2align 6
.amdhsa_kernel concat_heads__gqa_block_cached__gqa_block_cached__near_ridge_kernel
  .amdhsa_next_free_vgpr 256
  .amdhsa_next_free_sgpr 102
  .amdhsa_accum_offset 256
  .amdhsa_group_segment_fixed_size 0
  .amdhsa_kernarg_size 104
  .amdhsa_user_sgpr_count 2
  .amdhsa_user_sgpr_kernarg_segment_ptr 1
  .amdhsa_system_sgpr_workgroup_id_x 1
.end_amdhsa_kernel
```
